```python
import torch

def _softmax(x, axis=-1):
    return torch.softmax(x, dim=axis)
def _gelu(x):
    return torch.nn.functional.gelu(x, approximate="tanh")
def _silu(x):
    return torch.nn.functional.silu(x)
def _sigmoid(x):
    return torch.sigmoid(x)
def _layernorm(x, axis=-1, eps=1e-5):
    m = x.mean(dim=axis, keepdim=True)
    v = x.var(dim=axis, keepdim=True, unbiased=False)
    return (x - m) / torch.sqrt(v + eps)
def _scatter_add(tgt, idx, src, axis=0):
    return tgt.clone().index_add_(axis, idx, src)
def _segment_sum(src, seg, n):
    out = torch.zeros((n,) + src.shape[1:], dtype=src.dtype)
    return out.index_add_(0, seg, src)
def _pad(x, pw):
    flat = tuple(v for pair in reversed(pw) for v in pair)
    return torch.nn.functional.pad(x, flat)

kernel_name = 'sequential_preLN__ssm_conv_s4__glu_gated_reglu__prompt'

def setup_inputs():

    _w = (lambda a: (lambda t: t.to(torch.bfloat16) if t.is_floating_point() else t)(torch.as_tensor(a)))
    def _A_setup():
        B, L, D, N = 1, 2048, 640, 192
        A_re = -(lambda _x: torch.exp(torch.as_tensor(_x)))((lambda *s: torch.randn(*s, dtype=torch.bfloat16) * 3.2)(D, N))
        A_im = torch.pi * (lambda *s: torch.randn(*s, dtype=torch.bfloat16) * 0.05)(D, N)
        B_re = (lambda *s: torch.randn(*s, dtype=torch.bfloat16) * 0.05)(D, N)
        B_im = (lambda *s: torch.randn(*s, dtype=torch.bfloat16) * 0.1)(D, N)
        C_re = (lambda *s: torch.randn(*s, dtype=torch.bfloat16) * 0.1)(D, N)
        C_im = (lambda *s: torch.randn(*s, dtype=torch.bfloat16) * 0.05)(D, N)
        log_dt = (lambda *s: torch.randn(*s, dtype=torch.bfloat16) * 0.05)(D) * 0.5 - 4.0
        Dskip = (lambda *s: torch.randn(*s, dtype=torch.bfloat16) * 0.05)(D)
        return {
            "u": _w((lambda *s: torch.randn(*s, dtype=torch.bfloat16) * 0.05)(B, L, D)),
            "A_re": _w(A_re),
            "A_im": _w(A_im),
            "B_re": _w(B_re),
            "B_im": _w(B_im),
            "C_re": _w(C_re),
            "C_im": _w(C_im),
            "log_dt": _w(log_dt),
            "Dskip": _w(Dskip),
        }
    _A_in = _A_setup()

    def _B_setup():
        B, S, D, F = 1, 2048, 640, 1536
        return {
            "x": _w((lambda *s: torch.randn(*s, dtype=torch.bfloat16) * 0.05)(B, S, D)),
            "W_gate": _w((lambda *s: torch.randn(*s, dtype=torch.bfloat16) * 0.4)(D, F) * (2.0 / D) ** 0.5),
            "W_up": _w((lambda *s: torch.randn(*s, dtype=torch.bfloat16) * 0.4)(D, F) * (2.0 / D) ** 0.5),
            "W_down": _w((lambda *s: torch.randn(*s, dtype=torch.bfloat16) * 0.4)(F, D) * (1.0 / F) ** 0.5),
        }
    _B_in = _B_setup()

    return {
        "A_u": _A_in["u"],
        "A_A_re": _A_in["A_re"],
        "A_A_im": _A_in["A_im"],
        "A_B_re": _A_in["B_re"],
        "A_B_im": _A_in["B_im"],
        "A_C_re": _A_in["C_re"],
        "A_C_im": _A_in["C_im"],
        "A_log_dt": _A_in["log_dt"],
        "A_Dskip": _A_in["Dskip"],
        "B_x": _B_in["x"],
        "B_W_gate": _B_in["W_gate"],
        "B_W_up": _B_in["W_up"],
        "B_W_down": _B_in["W_down"],
    }

def reference(A_u, A_A_re, A_A_im, A_B_re, A_B_im, A_C_re, A_C_im, A_log_dt, A_Dskip, B_x, B_W_gate, B_W_up, B_W_down):
    def _A_ref(u, A_re, A_im, B_re, B_im, C_re, C_im, log_dt, Dskip):
        Bsz, L, D = u.shape
        dt = torch.exp(log_dt)[:, None]
        A = A_re + 1j * A_im
        Bc = B_re + 1j * B_im
        Cc = C_re + 1j * C_im
        logdA = dt * A
        dB = dt * Bc
        l = (lambda x, dt: x.to(dt))(torch.arange(L), A_re.dtype)
        P = torch.exp(logdA[:, :, None] * l[None, None, :])
        K = torch.einsum("dn,dnl,dn->dl", Cc, P, dB).real
        L2 = 2 * L
        Kp = _pad(K, ((0, 0), (0, L)))
        up = (lambda x, *d: x.permute(*d))(u, 0, 2, 1)
        up = _pad(up, ((0, 0), (0, 0), (0, L)))
        Kf = (lambda x, axes=(-2,-1): torch.fft.rfft2(x.float(), dim=axes))(Kp[:, None, :], axes=(-2, -1))
        Uf = (lambda x, axes=(-2,-1): torch.fft.rfft2(x.float(), dim=axes))(up[:, :, None, :], axes=(-2, -1))
        Yf = Uf * Kf[None, :, :, :]
        y = (lambda x, s, axes=(-2,-1): torch.fft.irfft2(x, s=s, dim=axes).to(torch.bfloat16))(Yf, (1, L2), axes=(-2, -1))[:, :, 0, :L]
        y = (lambda x, *d: x.permute(*d))(y, 0, 2, 1) + u * Dskip[None, None, :]
        return y

    def _B_ref(x, W_gate, W_up, W_down):
        gate = torch.einsum("bsd,df->bsf", x, W_gate)
        up = torch.einsum("bsd,df->bsf", x, W_up)
        gate = gate * (lambda x, dt: x.to(dt))(gate > 0, gate.dtype)
        h = gate * up
        return torch.einsum("bsf,fd->bsd", h, W_down)

    x = A_u
    h = x + _A_ref(_layernorm(x, axis=-1), A_A_re, A_A_im, A_B_re, A_B_im, A_C_re, A_C_im, A_log_dt, A_Dskip)
    h2 = h + _B_ref(_layernorm(h, axis=-1), B_W_gate, B_W_up, B_W_down)
    return h2
```

```asm
; @launch kernel=k1_kernel grid=(768,1,1) block=(256,1,1) lds=53760
; @launch kernel=k3_kernel grid=(256,1,1) block=(512,1,1) lds=163840
.amdgcn_target "amdgcn-amd-amdhsa--gfx950"
.text
.globl k1_kernel
.p2align 8
.type k1_kernel,@function
k1_kernel:
    s_cmp_ge_u32 s2, 768
    s_cbranch_scc1 K1_END
    s_sub_u32 s3, s2, 744
    s_cmp_ge_u32 s3, 16
    s_cbranch_scc1 K1_NOPF
    v_lshlrev_b32 v1, 7, v0
    s_getpc_b64 s[64:65]
PFH3:
    s_mov_b32 s66, k3_kernel-PFH3
    s_mov_b32 s67, 0x20000
    buffer_load_dword v164, v1, s[64:67], 0 offen
K1_NOPF:
    s_cmp_ge_u32 s2, 128
    s_cbranch_scc1 K1_KGEN
    s_setprio 3
    s_load_dwordx2 s[4:5], s[0:1], 0
    s_load_dwordx4 s[52:55], s[0:1], 112
    s_load_dwordx4 s[56:59], s[0:1], 80
    s_load_dwordx2 s[60:61], s[0:1], 96
    v_lshrrev_b32 v1, 4, v0
    v_and_b32 v2, 15, v0
    v_mul_u32_u24 v3, 1280, v1
    v_lshl_add_u32 v3, v2, 4, v3
    s_mul_i32 s3, s2, 20480
    v_mul_u32_u24 v4, 1296, v1
    v_lshl_add_u32 v4, v2, 4, v4
    v_lshrrev_b32 v34, 6, v0
    v_and_b32 v7, 63, v0
    v_readfirstlane_b32 s22, v34
    v_lshlrev_b32 v70, 4, v7
    s_lshl_b32 s21, s2, 2
    s_add_u32 s21, s21, s22
    s_waitcnt lgkmcnt(0)
    s_add_u32 s16, s54, 0x10c0000
    s_addc_u32 s17, s55, 0
    s_mov_b32 s18, 0xa000
    s_mov_b32 s19, 0x20000
    v_mov_b32 v72, 0
    s_lshl_b32 s65, s2, 7
    s_add_u32 s65, s65, 0x4000
    s_mov_b32 s8, s4
    s_mov_b32 s9, s5
    s_mov_b32 s10, 0x280000
    s_mov_b32 s11, 0x20000
    buffer_load_dwordx4 v[8:11], v3, s[8:11], s3 offen offset:0
    buffer_load_dwordx4 v[12:15], v3, s[8:11], s3 offen offset:256
    buffer_load_dwordx4 v[16:19], v3, s[8:11], s3 offen offset:512
    buffer_load_dwordx4 v[20:23], v3, s[8:11], s3 offen offset:768
    buffer_load_dwordx4 v[24:27], v3, s[8:11], s3 offen offset:1024
    s_mov_b32 s24, s52
    s_mov_b32 s25, s53
    s_mov_b32 s26, 0x100
    s_mov_b32 s27, 0x20000
    v_mov_b32 v72, 0
    v_mov_b32 v73, 0
    v_mov_b32 v74, 0
    v_mov_b32 v75, 0
    s_mov_b32 s12, s54
    s_mov_b32 s13, s55
    s_mov_b32 s14, 0x500000
    s_mov_b32 s15, 0x20000
    v_bfe_u32 v30, v0, 4, 1
    v_bfe_u32 v31, v0, 5, 1
    v_bfe_u32 v32, v0, 2, 2
    v_and_b32 v33, 3, v0
    v_mul_u32_u24 v35, 320, v34
    v_lshl_add_u32 v35, v31, 5, v35
    v_lshl_add_u32 v35, v33, 3, v35
    v_lshlrev_b32 v36, 1, v30
    v_lshl_add_u32 v36, v32, 2, v36
    v_mul_u32_u24 v36, 1296, v36
    v_add_u32 v36, v36, v35
    s_mul_i32 s23, s22, 3072
    s_add_u32 s23, s23, 41472
    v_lshl_add_u32 v38, v31, 4, v2
    v_mul_u32_u24 v38, 48, v38
    v_lshl_add_u32 v38, v30, 4, v38
    v_add_u32 v38, s23, v38
    v_lshrrev_b32 v39, 1, v7
    v_mul_u32_u24 v39, 48, v39
    v_and_b32 v69, 1, v7
    v_lshl_add_u32 v39, v69, 4, v39
    v_add_u32 v39, s23, v39
    s_mov_b32 s20, 0x3f803f80
    v_mov_b32 v5, 0
    v_mov_b32 v6, 0
    v_mov_b32 v28, 0
    v_mov_b32 v29, 0
    v_mov_b32 v71, 1
    s_waitcnt vmcnt(4)
    v_dot2_f32_bf16 v28, v8, s20, v28
    v_dot2_f32_bf16 v29, v8, v8, v29
    v_dot2_f32_bf16 v5, v9, s20, v5
    v_dot2_f32_bf16 v6, v9, v9, v6
    v_dot2_f32_bf16 v28, v10, s20, v28
    v_dot2_f32_bf16 v29, v10, v10, v29
    v_dot2_f32_bf16 v5, v11, s20, v5
    v_dot2_f32_bf16 v6, v11, v11, v6
    s_waitcnt vmcnt(3)
    v_dot2_f32_bf16 v28, v12, s20, v28
    v_dot2_f32_bf16 v29, v12, v12, v29
    v_dot2_f32_bf16 v5, v13, s20, v5
    v_dot2_f32_bf16 v6, v13, v13, v6
    v_dot2_f32_bf16 v28, v14, s20, v28
    v_dot2_f32_bf16 v29, v14, v14, v29
    v_dot2_f32_bf16 v5, v15, s20, v5
    v_dot2_f32_bf16 v6, v15, v15, v6
    s_waitcnt vmcnt(2)
    v_dot2_f32_bf16 v28, v16, s20, v28
    v_dot2_f32_bf16 v29, v16, v16, v29
    v_dot2_f32_bf16 v5, v17, s20, v5
    v_dot2_f32_bf16 v6, v17, v17, v6
    v_dot2_f32_bf16 v28, v18, s20, v28
    v_dot2_f32_bf16 v29, v18, v18, v29
    v_dot2_f32_bf16 v5, v19, s20, v5
    v_dot2_f32_bf16 v6, v19, v19, v6
    s_waitcnt vmcnt(1)
    v_dot2_f32_bf16 v28, v20, s20, v28
    v_dot2_f32_bf16 v29, v20, v20, v29
    v_dot2_f32_bf16 v5, v21, s20, v5
    v_dot2_f32_bf16 v6, v21, v21, v6
    v_dot2_f32_bf16 v28, v22, s20, v28
    v_dot2_f32_bf16 v29, v22, v22, v29
    v_dot2_f32_bf16 v5, v23, s20, v5
    v_dot2_f32_bf16 v6, v23, v23, v6
    s_waitcnt vmcnt(0)
    v_dot2_f32_bf16 v28, v24, s20, v28
    v_dot2_f32_bf16 v29, v24, v24, v29
    v_dot2_f32_bf16 v5, v25, s20, v5
    v_dot2_f32_bf16 v6, v25, v25, v6
    v_dot2_f32_bf16 v28, v26, s20, v28
    v_dot2_f32_bf16 v29, v26, v26, v29
    v_dot2_f32_bf16 v5, v27, s20, v5
    v_dot2_f32_bf16 v6, v27, v27, v6
    s_nop 1
    v_add_f32 v5, v5, v28
    v_add_f32 v6, v6, v29
    s_nop 0
    v_add_f32_dpp v5, v5, v5 row_ror:8 row_mask:0xf bank_mask:0xf
    v_add_f32_dpp v6, v6, v6 row_ror:8 row_mask:0xf bank_mask:0xf
    s_nop 0
    v_add_f32_dpp v5, v5, v5 row_ror:4 row_mask:0xf bank_mask:0xf
    v_add_f32_dpp v6, v6, v6 row_ror:4 row_mask:0xf bank_mask:0xf
    s_nop 0
    v_add_f32_dpp v5, v5, v5 row_ror:2 row_mask:0xf bank_mask:0xf
    v_add_f32_dpp v6, v6, v6 row_ror:2 row_mask:0xf bank_mask:0xf
    s_nop 0
    v_add_f32_dpp v5, v5, v5 row_ror:1 row_mask:0xf bank_mask:0xf
    v_add_f32_dpp v6, v6, v6 row_ror:1 row_mask:0xf bank_mask:0xf
    v_mul_f32 v5, 0x3acccccd, v5
    v_mul_f32 v6, 0x3acccccd, v6
    v_fma_f32 v6, -v5, v5, v6
    v_max_f32 v6, 0, v6
    v_cvt_pk_bf16_f32 v5, v5, v5
    v_and_b32 v5, 0xffff0000, v5
    v_cvt_pk_bf16_f32 v6, v6, v6
    v_and_b32 v6, 0xffff0000, v6
    v_add_f32 v6, 0x3727c5ac, v6
    v_cvt_pk_bf16_f32 v6, v6, v6
    v_and_b32 v6, 0xffff0000, v6
    v_sqrt_f32 v6, v6
    s_nop 0
    v_cvt_pk_bf16_f32 v6, v6, v6
    v_and_b32 v6, 0xffff0000, v6
    v_lshlrev_b32 v29, 2, v1
    s_lshl_b32 s64, s2, 6
    s_add_u32 s66, s64, 0x2000
    s_mov_b32 exec_lo, 0x00010001
    s_mov_b32 exec_hi, 0x00010001
    v_lshrrev_b32 v28, 16, v5
    v_or_b32 v28, v28, v6
    buffer_store_dword v28, v29, s[16:19], s64 offen sc1
    s_mov_b64 exec, -1
    v_rcp_f32 v6, v6
    s_nop 0
    v_mul_f32 v5, v5, v6
    v_lshlrev_b32 v60, 16, v8
    v_and_b32 v61, 0xffff0000, v8
    v_lshlrev_b32 v62, 16, v9
    v_and_b32 v63, 0xffff0000, v9
    v_lshlrev_b32 v64, 16, v10
    v_and_b32 v65, 0xffff0000, v10
    v_lshlrev_b32 v66, 16, v11
    v_and_b32 v67, 0xffff0000, v11
    v_fma_f32 v60, v60, v6, -v5
    v_fma_f32 v61, v61, v6, -v5
    v_fma_f32 v62, v62, v6, -v5
    v_fma_f32 v63, v63, v6, -v5
    v_fma_f32 v64, v64, v6, -v5
    v_fma_f32 v65, v65, v6, -v5
    v_fma_f32 v66, v66, v6, -v5
    v_fma_f32 v67, v67, v6, -v5
    v_cvt_pk_bf16_f32 v40, v60, v61
    v_cvt_pk_bf16_f32 v41, v62, v63
    v_cvt_pk_bf16_f32 v42, v64, v65
    v_cvt_pk_bf16_f32 v43, v66, v67
    ds_write_b128 v4, v[40:43] offset:0
    v_lshlrev_b32 v60, 16, v12
    v_and_b32 v61, 0xffff0000, v12
    v_lshlrev_b32 v62, 16, v13
    v_and_b32 v63, 0xffff0000, v13
    v_lshlrev_b32 v64, 16, v14
    v_and_b32 v65, 0xffff0000, v14
    v_lshlrev_b32 v66, 16, v15
    v_and_b32 v67, 0xffff0000, v15
    v_fma_f32 v60, v60, v6, -v5
    v_fma_f32 v61, v61, v6, -v5
    v_fma_f32 v62, v62, v6, -v5
    v_fma_f32 v63, v63, v6, -v5
    v_fma_f32 v64, v64, v6, -v5
    v_fma_f32 v65, v65, v6, -v5
    v_fma_f32 v66, v66, v6, -v5
    v_fma_f32 v67, v67, v6, -v5
    v_cvt_pk_bf16_f32 v44, v60, v61
    v_cvt_pk_bf16_f32 v45, v62, v63
    v_cvt_pk_bf16_f32 v46, v64, v65
    v_cvt_pk_bf16_f32 v47, v66, v67
    ds_write_b128 v4, v[44:47] offset:256
    v_lshlrev_b32 v60, 16, v16
    v_and_b32 v61, 0xffff0000, v16
    v_lshlrev_b32 v62, 16, v17
    v_and_b32 v63, 0xffff0000, v17
    v_lshlrev_b32 v64, 16, v18
    v_and_b32 v65, 0xffff0000, v18
    v_lshlrev_b32 v66, 16, v19
    v_and_b32 v67, 0xffff0000, v19
    v_fma_f32 v60, v60, v6, -v5
    v_fma_f32 v61, v61, v6, -v5
    v_fma_f32 v62, v62, v6, -v5
    v_fma_f32 v63, v63, v6, -v5
    v_fma_f32 v64, v64, v6, -v5
    v_fma_f32 v65, v65, v6, -v5
    v_fma_f32 v66, v66, v6, -v5
    v_fma_f32 v67, v67, v6, -v5
    v_cvt_pk_bf16_f32 v48, v60, v61
    v_cvt_pk_bf16_f32 v49, v62, v63
    v_cvt_pk_bf16_f32 v50, v64, v65
    v_cvt_pk_bf16_f32 v51, v66, v67
    ds_write_b128 v4, v[48:51] offset:512
    v_lshlrev_b32 v60, 16, v20
    v_and_b32 v61, 0xffff0000, v20
    v_lshlrev_b32 v62, 16, v21
    v_and_b32 v63, 0xffff0000, v21
    v_lshlrev_b32 v64, 16, v22
    v_and_b32 v65, 0xffff0000, v22
    v_lshlrev_b32 v66, 16, v23
    v_and_b32 v67, 0xffff0000, v23
    v_fma_f32 v60, v60, v6, -v5
    v_fma_f32 v61, v61, v6, -v5
    v_fma_f32 v62, v62, v6, -v5
    v_fma_f32 v63, v63, v6, -v5
    v_fma_f32 v64, v64, v6, -v5
    v_fma_f32 v65, v65, v6, -v5
    v_fma_f32 v66, v66, v6, -v5
    v_fma_f32 v67, v67, v6, -v5
    v_cvt_pk_bf16_f32 v52, v60, v61
    v_cvt_pk_bf16_f32 v53, v62, v63
    v_cvt_pk_bf16_f32 v54, v64, v65
    v_cvt_pk_bf16_f32 v55, v66, v67
    ds_write_b128 v4, v[52:55] offset:768
    v_lshlrev_b32 v60, 16, v24
    v_and_b32 v61, 0xffff0000, v24
    v_lshlrev_b32 v62, 16, v25
    v_and_b32 v63, 0xffff0000, v25
    v_lshlrev_b32 v64, 16, v26
    v_and_b32 v65, 0xffff0000, v26
    v_lshlrev_b32 v66, 16, v27
    v_and_b32 v67, 0xffff0000, v27
    v_fma_f32 v60, v60, v6, -v5
    v_fma_f32 v61, v61, v6, -v5
    v_fma_f32 v62, v62, v6, -v5
    v_fma_f32 v63, v63, v6, -v5
    v_fma_f32 v64, v64, v6, -v5
    v_fma_f32 v65, v65, v6, -v5
    v_fma_f32 v66, v66, v6, -v5
    v_fma_f32 v67, v67, v6, -v5
    v_cvt_pk_bf16_f32 v56, v60, v61
    v_cvt_pk_bf16_f32 v57, v62, v63
    v_cvt_pk_bf16_f32 v58, v64, v65
    v_cvt_pk_bf16_f32 v59, v66, v67
    ds_write_b128 v4, v[56:59] offset:1024
    buffer_load_dword v73, v72, s[24:27], 0 offen sc1
    s_waitcnt lgkmcnt(0)
    s_barrier
    s_mul_i32 s23, s22, 5120
    s_add_u32 s3, s3, s23
    s_add_u32 s62, s3, 4096
    s_add_u32 s63, s3, 0x280000
    ds_read_b64_tr_b16 v[76:77], v36 offset:0
    ds_read_b64_tr_b16 v[78:79], v36 offset:1296
    ds_read_b64_tr_b16 v[80:81], v36 offset:64
    ds_read_b64_tr_b16 v[82:83], v36 offset:1360
    ds_read_b64_tr_b16 v[84:85], v36 offset:128
    ds_read_b64_tr_b16 v[86:87], v36 offset:1424
    ds_read_b64_tr_b16 v[88:89], v36 offset:192
    ds_read_b64_tr_b16 v[90:91], v36 offset:1488
    ds_read_b64_tr_b16 v[92:93], v36 offset:256
    ds_read_b64_tr_b16 v[94:95], v36 offset:1552
    s_waitcnt lgkmcnt(8)
    ds_write_b128 v38, v[76:79] offset:0
    ds_read_b128 v[8:11], v39 offset:0
    s_waitcnt lgkmcnt(8)
    ds_write_b128 v38, v[80:83] offset:1536
    ds_read_b128 v[12:15], v39 offset:1536
    s_waitcnt lgkmcnt(2)
    buffer_store_dwordx4 v[8:11], v70, s[12:15], s3 offen offset:0 sc1
    ds_write_b128 v38, v[84:87] offset:0
    ds_read_b128 v[16:19], v39 offset:0
    s_waitcnt lgkmcnt(2)
    buffer_store_dwordx4 v[12:15], v70, s[12:15], s3 offen offset:1024 sc1
    ds_write_b128 v38, v[88:91] offset:1536
    ds_read_b128 v[20:23], v39 offset:1536
    s_waitcnt lgkmcnt(2)
    buffer_store_dwordx4 v[16:19], v70, s[12:15], s3 offen offset:2048 sc1
    ds_write_b128 v38, v[92:95] offset:0
    ds_read_b128 v[24:27], v39 offset:0
    s_waitcnt lgkmcnt(2)
    buffer_store_dwordx4 v[20:23], v70, s[12:15], s3 offen offset:3072 sc1
    s_waitcnt lgkmcnt(0)
    buffer_store_dwordx4 v[24:27], v70, s[12:15], s62 offen offset:0 sc1
    v_lshrrev_b32 v9, 4, v7
    s_waitcnt vmcnt(0)
    s_barrier
    s_cmp_lg_u32 s22, 0
    s_cbranch_scc1 K1_NOFLAG
    s_mov_b32 s38, 0
K1_PI:
    v_cmp_ne_u32 vcc, 1, v73
    s_cbranch_vccz K1_PID
    s_add_u32 s38, s38, 1
    s_cmp_ge_u32 s38, 200000
    s_cbranch_scc1 K1_PID
    buffer_load_dword v73, v72, s[24:27], 0 offen sc1
    s_waitcnt vmcnt(0)
    s_branch K1_PI
K1_PID:
    s_mov_b64 exec, 1
    buffer_store_dword v71, v72, s[16:19], s65 offen sc1
    s_add_u32 s65, s65, 0x4000
    buffer_store_dword v71, v72, s[16:19], s65 offen sc1
    s_mov_b64 exec, -1
    s_waitcnt vmcnt(0)
K1_NOFLAG:
    s_setprio 1
    s_cmp_ge_u32 s2, 96
    s_cbranch_scc1 K1_W2
    s_and_b32 s28, s2, 7
    s_mul_i32 s28, s28, 12
    s_lshr_b32 s29, s2, 3
    s_add_u32 s28, s28, s29
    s_cmp_ge_u32 s28, 48
    s_cselect_b32 s8, s58, s56
    s_cselect_b32 s9, s59, s57
    s_cselect_b32 s31, 48, 0
    s_cselect_b32 s32, 6144, 0
    s_mov_b32 s10, 1966080
    s_mov_b32 s11, 0x20000
    s_sub_u32 s31, s28, s31
    s_mul_i32 s33, s22, 491520
    s_lshl_b32 s34, s31, 6
    s_add_u32 s33, s33, s34
    v_lshrrev_b32 v3, 2, v7
    v_mul_u32_u24 v8, 3072, v3
    v_and_b32 v12, 3, v7
    v_lshl_add_u32 v8, v12, 4, v8
    s_mul_i32 s23, s22, 10240
    v_lshlrev_b32 v10, 6, v3
    v_lshl_add_u32 v10, v12, 3, v10
    v_add_u32 v10, s23, v10
    s_mul_i32 s34, s31, 0x5556
    s_lshr_b32 s34, s34, 16
    s_mul_i32 s35, s34, 3
    s_sub_u32 s35, s31, s35
    s_mul_i32 s34, s34, 245760
    s_add_u32 s34, s34, s32
    s_mul_i32 s36, s22, 61440
    s_add_u32 s34, s34, s36
    s_lshl_b32 s35, s35, 3
    s_lshr_b32 s36, 0x435210, s35
    s_bfe_u32 s37, s36, 0x40004
    s_and_b32 s36, s36, 15
    s_lshl_b32 s36, s36, 10
    s_lshl_b32 s37, s37, 10
    s_add_u32 s36, s36, s34
    s_add_u32 s37, s37, s34
    s_add_u32 s40, s54, 0x1200000
    s_addc_u32 s41, s55, 0
    s_mov_b32 s42, 0x3c0000
    s_mov_b32 s43, 0x20000
    s_barrier
    s_add_u32 m0, s23, 0
    s_nop 0
    buffer_load_dwordx4 v8, s[8:11], s33 offen  lds
    s_add_u32 s33, s33, 49152
    s_add_u32 m0, s23, 1024
    s_nop 0
    buffer_load_dwordx4 v8, s[8:11], s33 offen  lds
    s_add_u32 s33, s33, 49152
    s_add_u32 m0, s23, 2048
    s_nop 0
    buffer_load_dwordx4 v8, s[8:11], s33 offen  lds
    s_add_u32 s33, s33, 49152
    s_add_u32 m0, s23, 3072
    s_nop 0
    buffer_load_dwordx4 v8, s[8:11], s33 offen  lds
    s_add_u32 s33, s33, 49152
    s_add_u32 m0, s23, 4096
    s_nop 0
    buffer_load_dwordx4 v8, s[8:11], s33 offen  lds
    s_add_u32 s33, s33, 49152
    s_add_u32 m0, s23, 5120
    s_nop 0
    buffer_load_dwordx4 v8, s[8:11], s33 offen  lds
    s_add_u32 s33, s33, 49152
    s_add_u32 m0, s23, 6144
    s_nop 0
    buffer_load_dwordx4 v8, s[8:11], s33 offen  lds
    s_add_u32 s33, s33, 49152
    s_add_u32 m0, s23, 7168
    s_nop 0
    buffer_load_dwordx4 v8, s[8:11], s33 offen  lds
    s_add_u32 s33, s33, 49152
    s_add_u32 m0, s23, 8192
    s_nop 0
    buffer_load_dwordx4 v8, s[8:11], s33 offen  lds
    s_add_u32 s33, s33, 49152
    s_add_u32 m0, s23, 9216
    s_nop 0
    buffer_load_dwordx4 v8, s[8:11], s33 offen  lds
    s_add_u32 s33, s33, 49152
    v_mov_b32 v56, 0
    v_mov_b32 v57, 0
    s_waitcnt vmcnt(8)
    ds_read_b64_tr_b16 v[16:17], v10 offset:0
    ds_read_b64_tr_b16 v[18:19], v10 offset:1024
    ds_read_b64_tr_b16 v[20:21], v10 offset:32
    ds_read_b64_tr_b16 v[22:23], v10 offset:1056
    s_waitcnt vmcnt(6)
    ds_read_b64_tr_b16 v[24:25], v10 offset:2048
    ds_read_b64_tr_b16 v[26:27], v10 offset:3072
    ds_read_b64_tr_b16 v[28:29], v10 offset:2080
    ds_read_b64_tr_b16 v[30:31], v10 offset:3104
    s_waitcnt lgkmcnt(4)
    v_dot2_f32_bf16 v56, v16, s20, v56
    v_dot2_f32_bf16 v57, v20, s20, v57
    v_dot2_f32_bf16 v56, v17, s20, v56
    v_dot2_f32_bf16 v57, v21, s20, v57
    v_dot2_f32_bf16 v56, v18, s20, v56
    v_dot2_f32_bf16 v57, v22, s20, v57
    v_dot2_f32_bf16 v56, v19, s20, v56
    v_dot2_f32_bf16 v57, v23, s20, v57
    s_waitcnt vmcnt(4)
    ds_read_b64_tr_b16 v[32:33], v10 offset:4096
    ds_read_b64_tr_b16 v[34:35], v10 offset:5120
    ds_read_b64_tr_b16 v[36:37], v10 offset:4128
    ds_read_b64_tr_b16 v[38:39], v10 offset:5152
    s_waitcnt lgkmcnt(4)
    v_dot2_f32_bf16 v56, v24, s20, v56
    v_dot2_f32_bf16 v57, v28, s20, v57
    v_dot2_f32_bf16 v56, v25, s20, v56
    v_dot2_f32_bf16 v57, v29, s20, v57
    v_dot2_f32_bf16 v56, v26, s20, v56
    v_dot2_f32_bf16 v57, v30, s20, v57
    v_dot2_f32_bf16 v56, v27, s20, v56
    v_dot2_f32_bf16 v57, v31, s20, v57
    s_waitcnt vmcnt(2)
    ds_read_b64_tr_b16 v[40:41], v10 offset:6144
    ds_read_b64_tr_b16 v[42:43], v10 offset:7168
    ds_read_b64_tr_b16 v[44:45], v10 offset:6176
    ds_read_b64_tr_b16 v[46:47], v10 offset:7200
    s_waitcnt lgkmcnt(4)
    v_dot2_f32_bf16 v56, v32, s20, v56
    v_dot2_f32_bf16 v57, v36, s20, v57
    v_dot2_f32_bf16 v56, v33, s20, v56
    v_dot2_f32_bf16 v57, v37, s20, v57
    v_dot2_f32_bf16 v56, v34, s20, v56
    v_dot2_f32_bf16 v57, v38, s20, v57
    v_dot2_f32_bf16 v56, v35, s20, v56
    v_dot2_f32_bf16 v57, v39, s20, v57
    s_waitcnt vmcnt(0)
    ds_read_b64_tr_b16 v[48:49], v10 offset:8192
    ds_read_b64_tr_b16 v[50:51], v10 offset:9216
    ds_read_b64_tr_b16 v[52:53], v10 offset:8224
    ds_read_b64_tr_b16 v[54:55], v10 offset:9248
    s_waitcnt lgkmcnt(4)
    v_dot2_f32_bf16 v56, v40, s20, v56
    v_dot2_f32_bf16 v57, v44, s20, v57
    v_dot2_f32_bf16 v56, v41, s20, v56
    v_dot2_f32_bf16 v57, v45, s20, v57
    v_dot2_f32_bf16 v56, v42, s20, v56
    v_dot2_f32_bf16 v57, v46, s20, v57
    v_dot2_f32_bf16 v56, v43, s20, v56
    v_dot2_f32_bf16 v57, v47, s20, v57
    s_waitcnt lgkmcnt(0)
    v_dot2_f32_bf16 v56, v48, s20, v56
    v_dot2_f32_bf16 v57, v52, s20, v57
    v_dot2_f32_bf16 v56, v49, s20, v56
    v_dot2_f32_bf16 v57, v53, s20, v57
    v_dot2_f32_bf16 v56, v50, s20, v56
    v_dot2_f32_bf16 v57, v54, s20, v57
    v_dot2_f32_bf16 v56, v51, s20, v56
    v_dot2_f32_bf16 v57, v55, s20, v57
    v_lshlrev_b32 v13, 3, v0
    s_nop 1
    ds_write_b64 v13, v[56:57] offset:40960
    v_lshlrev_b32 v13, 3, v2
    s_waitcnt lgkmcnt(0)
    s_barrier
    ds_read_b64 v[76:77], v13 offset:40960
    ds_read_b64 v[78:79], v13 offset:41088
    ds_read_b64 v[80:81], v13 offset:41216
    ds_read_b64 v[82:83], v13 offset:41344
    ds_read_b64 v[84:85], v13 offset:41472
    ds_read_b64 v[86:87], v13 offset:41600
    ds_read_b64 v[88:89], v13 offset:41728
    ds_read_b64 v[90:91], v13 offset:41856
    ds_read_b64 v[92:93], v13 offset:41984
    ds_read_b64 v[94:95], v13 offset:42112
    ds_read_b64 v[96:97], v13 offset:42240
    ds_read_b64 v[98:99], v13 offset:42368
    ds_read_b64 v[100:101], v13 offset:42496
    ds_read_b64 v[102:103], v13 offset:42624
    ds_read_b64 v[104:105], v13 offset:42752
    ds_read_b64 v[106:107], v13 offset:42880
    s_waitcnt lgkmcnt(0)
    v_pk_add_f32 v[76:77], v[76:77], v[92:93]
    v_pk_add_f32 v[78:79], v[78:79], v[94:95]
    v_pk_add_f32 v[80:81], v[80:81], v[96:97]
    v_pk_add_f32 v[82:83], v[82:83], v[98:99]
    v_pk_add_f32 v[84:85], v[84:85], v[100:101]
    v_pk_add_f32 v[86:87], v[86:87], v[102:103]
    v_pk_add_f32 v[88:89], v[88:89], v[104:105]
    v_pk_add_f32 v[90:91], v[90:91], v[106:107]
    v_pk_add_f32 v[76:77], v[76:77], v[84:85]
    v_pk_add_f32 v[78:79], v[78:79], v[86:87]
    v_pk_add_f32 v[80:81], v[80:81], v[88:89]
    v_pk_add_f32 v[82:83], v[82:83], v[90:91]
    v_pk_add_f32 v[76:77], v[76:77], v[80:81]
    v_pk_add_f32 v[78:79], v[78:79], v[82:83]
    v_pk_add_f32 v[76:77], v[76:77], v[78:79]
    v_mul_f32 v76, 0x3acccccd, v76
    v_mul_f32 v77, 0x3acccccd, v77
    v_lshlrev_b32 v60, 16, v16
    v_and_b32 v61, 0xffff0000, v16
    v_lshlrev_b32 v62, 16, v17
    v_and_b32 v63, 0xffff0000, v17
    v_lshlrev_b32 v64, 16, v18
    v_and_b32 v65, 0xffff0000, v18
    v_lshlrev_b32 v66, 16, v19
    v_and_b32 v67, 0xffff0000, v19
    v_sub_f32 v60, v60, v76
    v_sub_f32 v61, v61, v76
    v_sub_f32 v62, v62, v76
    v_sub_f32 v63, v63, v76
    v_sub_f32 v64, v64, v76
    v_sub_f32 v65, v65, v76
    v_sub_f32 v66, v66, v76
    v_sub_f32 v67, v67, v76
    v_cvt_pk_bf16_f32 v16, v60, v61
    v_cvt_pk_bf16_f32 v17, v62, v63
    v_cvt_pk_bf16_f32 v18, v64, v65
    v_cvt_pk_bf16_f32 v19, v66, v67
    v_lshlrev_b32 v60, 16, v20
    v_and_b32 v61, 0xffff0000, v20
    v_lshlrev_b32 v62, 16, v21
    v_and_b32 v63, 0xffff0000, v21
    v_lshlrev_b32 v64, 16, v22
    v_and_b32 v65, 0xffff0000, v22
    v_lshlrev_b32 v66, 16, v23
    v_and_b32 v67, 0xffff0000, v23
    v_sub_f32 v60, v60, v77
    v_sub_f32 v61, v61, v77
    v_sub_f32 v62, v62, v77
    v_sub_f32 v63, v63, v77
    v_sub_f32 v64, v64, v77
    v_sub_f32 v65, v65, v77
    v_sub_f32 v66, v66, v77
    v_sub_f32 v67, v67, v77
    v_cvt_pk_bf16_f32 v20, v60, v61
    v_cvt_pk_bf16_f32 v21, v62, v63
    v_cvt_pk_bf16_f32 v22, v64, v65
    v_cvt_pk_bf16_f32 v23, v66, v67
    v_lshlrev_b32 v60, 16, v24
    v_and_b32 v61, 0xffff0000, v24
    v_lshlrev_b32 v62, 16, v25
    v_and_b32 v63, 0xffff0000, v25
    v_lshlrev_b32 v64, 16, v26
    v_and_b32 v65, 0xffff0000, v26
    v_lshlrev_b32 v66, 16, v27
    v_and_b32 v67, 0xffff0000, v27
    v_sub_f32 v60, v60, v76
    v_sub_f32 v61, v61, v76
    v_sub_f32 v62, v62, v76
    v_sub_f32 v63, v63, v76
    v_sub_f32 v64, v64, v76
    v_sub_f32 v65, v65, v76
    v_sub_f32 v66, v66, v76
    v_sub_f32 v67, v67, v76
    v_cvt_pk_bf16_f32 v24, v60, v61
    v_cvt_pk_bf16_f32 v25, v62, v63
    v_cvt_pk_bf16_f32 v26, v64, v65
    v_cvt_pk_bf16_f32 v27, v66, v67
    v_lshlrev_b32 v60, 16, v28
    v_and_b32 v61, 0xffff0000, v28
    v_lshlrev_b32 v62, 16, v29
    v_and_b32 v63, 0xffff0000, v29
    v_lshlrev_b32 v64, 16, v30
    v_and_b32 v65, 0xffff0000, v30
    v_lshlrev_b32 v66, 16, v31
    v_and_b32 v67, 0xffff0000, v31
    v_sub_f32 v60, v60, v77
    v_sub_f32 v61, v61, v77
    v_sub_f32 v62, v62, v77
    v_sub_f32 v63, v63, v77
    v_sub_f32 v64, v64, v77
    v_sub_f32 v65, v65, v77
    v_sub_f32 v66, v66, v77
    v_sub_f32 v67, v67, v77
    v_cvt_pk_bf16_f32 v28, v60, v61
    v_cvt_pk_bf16_f32 v29, v62, v63
    v_cvt_pk_bf16_f32 v30, v64, v65
    v_cvt_pk_bf16_f32 v31, v66, v67
    v_lshlrev_b32 v60, 16, v32
    v_and_b32 v61, 0xffff0000, v32
    v_lshlrev_b32 v62, 16, v33
    v_and_b32 v63, 0xffff0000, v33
    v_lshlrev_b32 v64, 16, v34
    v_and_b32 v65, 0xffff0000, v34
    v_lshlrev_b32 v66, 16, v35
    v_and_b32 v67, 0xffff0000, v35
    v_sub_f32 v60, v60, v76
    v_sub_f32 v61, v61, v76
    v_sub_f32 v62, v62, v76
    v_sub_f32 v63, v63, v76
    v_sub_f32 v64, v64, v76
    v_sub_f32 v65, v65, v76
    v_sub_f32 v66, v66, v76
    v_sub_f32 v67, v67, v76
    v_cvt_pk_bf16_f32 v32, v60, v61
    v_cvt_pk_bf16_f32 v33, v62, v63
    v_cvt_pk_bf16_f32 v34, v64, v65
    v_cvt_pk_bf16_f32 v35, v66, v67
    v_lshlrev_b32 v60, 16, v36
    v_and_b32 v61, 0xffff0000, v36
    v_lshlrev_b32 v62, 16, v37
    v_and_b32 v63, 0xffff0000, v37
    v_lshlrev_b32 v64, 16, v38
    v_and_b32 v65, 0xffff0000, v38
    v_lshlrev_b32 v66, 16, v39
    v_and_b32 v67, 0xffff0000, v39
    v_sub_f32 v60, v60, v77
    v_sub_f32 v61, v61, v77
    v_sub_f32 v62, v62, v77
    v_sub_f32 v63, v63, v77
    v_sub_f32 v64, v64, v77
    v_sub_f32 v65, v65, v77
    v_sub_f32 v66, v66, v77
    v_sub_f32 v67, v67, v77
    v_cvt_pk_bf16_f32 v36, v60, v61
    v_cvt_pk_bf16_f32 v37, v62, v63
    v_cvt_pk_bf16_f32 v38, v64, v65
    v_cvt_pk_bf16_f32 v39, v66, v67
    v_lshlrev_b32 v60, 16, v40
    v_and_b32 v61, 0xffff0000, v40
    v_lshlrev_b32 v62, 16, v41
    v_and_b32 v63, 0xffff0000, v41
    v_lshlrev_b32 v64, 16, v42
    v_and_b32 v65, 0xffff0000, v42
    v_lshlrev_b32 v66, 16, v43
    v_and_b32 v67, 0xffff0000, v43
    v_sub_f32 v60, v60, v76
    v_sub_f32 v61, v61, v76
    v_sub_f32 v62, v62, v76
    v_sub_f32 v63, v63, v76
    v_sub_f32 v64, v64, v76
    v_sub_f32 v65, v65, v76
    v_sub_f32 v66, v66, v76
    v_sub_f32 v67, v67, v76
    v_cvt_pk_bf16_f32 v40, v60, v61
    v_cvt_pk_bf16_f32 v41, v62, v63
    v_cvt_pk_bf16_f32 v42, v64, v65
    v_cvt_pk_bf16_f32 v43, v66, v67
    v_lshlrev_b32 v60, 16, v44
    v_and_b32 v61, 0xffff0000, v44
    v_lshlrev_b32 v62, 16, v45
    v_and_b32 v63, 0xffff0000, v45
    v_lshlrev_b32 v64, 16, v46
    v_and_b32 v65, 0xffff0000, v46
    v_lshlrev_b32 v66, 16, v47
    v_and_b32 v67, 0xffff0000, v47
    v_sub_f32 v60, v60, v77
    v_sub_f32 v61, v61, v77
    v_sub_f32 v62, v62, v77
    v_sub_f32 v63, v63, v77
    v_sub_f32 v64, v64, v77
    v_sub_f32 v65, v65, v77
    v_sub_f32 v66, v66, v77
    v_sub_f32 v67, v67, v77
    v_cvt_pk_bf16_f32 v44, v60, v61
    v_cvt_pk_bf16_f32 v45, v62, v63
    v_cvt_pk_bf16_f32 v46, v64, v65
    v_cvt_pk_bf16_f32 v47, v66, v67
    v_lshlrev_b32 v60, 16, v48
    v_and_b32 v61, 0xffff0000, v48
    v_lshlrev_b32 v62, 16, v49
    v_and_b32 v63, 0xffff0000, v49
    v_lshlrev_b32 v64, 16, v50
    v_and_b32 v65, 0xffff0000, v50
    v_lshlrev_b32 v66, 16, v51
    v_and_b32 v67, 0xffff0000, v51
    v_sub_f32 v60, v60, v76
    v_sub_f32 v61, v61, v76
    v_sub_f32 v62, v62, v76
    v_sub_f32 v63, v63, v76
    v_sub_f32 v64, v64, v76
    v_sub_f32 v65, v65, v76
    v_sub_f32 v66, v66, v76
    v_sub_f32 v67, v67, v76
    v_cvt_pk_bf16_f32 v48, v60, v61
    v_cvt_pk_bf16_f32 v49, v62, v63
    v_cvt_pk_bf16_f32 v50, v64, v65
    v_cvt_pk_bf16_f32 v51, v66, v67
    v_lshlrev_b32 v60, 16, v52
    v_and_b32 v61, 0xffff0000, v52
    v_lshlrev_b32 v62, 16, v53
    v_and_b32 v63, 0xffff0000, v53
    v_lshlrev_b32 v64, 16, v54
    v_and_b32 v65, 0xffff0000, v54
    v_lshlrev_b32 v66, 16, v55
    v_and_b32 v67, 0xffff0000, v55
    v_sub_f32 v60, v60, v77
    v_sub_f32 v61, v61, v77
    v_sub_f32 v62, v62, v77
    v_sub_f32 v63, v63, v77
    v_sub_f32 v64, v64, v77
    v_sub_f32 v65, v65, v77
    v_sub_f32 v66, v66, v77
    v_sub_f32 v67, v67, v77
    v_cvt_pk_bf16_f32 v52, v60, v61
    v_cvt_pk_bf16_f32 v53, v62, v63
    v_cvt_pk_bf16_f32 v54, v64, v65
    v_cvt_pk_bf16_f32 v55, v66, v67
    buffer_store_dwordx4 v[16:19], v70, s[40:43], s36 offen sc1
    s_add_u32 s36, s36, 12288
    buffer_store_dwordx4 v[20:23], v70, s[40:43], s37 offen sc1
    s_add_u32 s37, s37, 12288
    buffer_store_dwordx4 v[24:27], v70, s[40:43], s36 offen sc1
    s_add_u32 s36, s36, 12288
    buffer_store_dwordx4 v[28:31], v70, s[40:43], s37 offen sc1
    s_add_u32 s37, s37, 12288
    buffer_store_dwordx4 v[32:35], v70, s[40:43], s36 offen sc1
    s_add_u32 s36, s36, 12288
    buffer_store_dwordx4 v[36:39], v70, s[40:43], s37 offen sc1
    s_add_u32 s37, s37, 12288
    buffer_store_dwordx4 v[40:43], v70, s[40:43], s36 offen sc1
    s_add_u32 s36, s36, 12288
    buffer_store_dwordx4 v[44:47], v70, s[40:43], s37 offen sc1
    s_add_u32 s37, s37, 12288
    buffer_store_dwordx4 v[48:51], v70, s[40:43], s36 offen sc1
    s_add_u32 s36, s36, 12288
    buffer_store_dwordx4 v[52:55], v70, s[40:43], s37 offen sc1
    s_add_u32 s37, s37, 12288
K1_LNEND:
    s_endpgm
K1_W2:
    s_sub_u32 s21, s2, 96
    s_lshr_b32 s21, s21, 3
    s_lshl_b32 s21, s21, 2
    s_add_u32 s21, s21, s22
    s_mul_i32 s23, s22, 8448
    s_mul_i32 s34, s21, 0x3334
    s_lshr_b32 s34, s34, 16
    s_mul_i32 s35, s34, 5
    s_sub_u32 s35, s21, s35
    s_and_b32 s37, s2, 7
    s_mul_i32 s37, s37, 3
    s_add_u32 s34, s34, s37
    s_mov_b32 s8, s60
    s_mov_b32 s9, s61
    s_mov_b32 s10, 0x1e0000
    s_mov_b32 s11, 0x20000
    s_add_u32 s40, s54, 0x1600000
    s_addc_u32 s41, s55, 0
    s_mov_b32 s42, 0x1e0000
    s_mov_b32 s43, 0x20000
    v_mul_u32_u24 v8, 10240, v9
    v_lshl_add_u32 v8, v2, 4, v8
    s_mul_i32 s36, s34, 81920
    s_lshl_b32 s37, s35, 8
    s_add_u32 s36, s36, s37
    v_and_b32 v12, 3, v7
    v_bfe_u32 v3, v7, 2, 3
    v_mul_u32_u24 v10, 1056, v3
    v_lshrrev_b32 v3, 5, v7
    v_lshl_add_u32 v10, v3, 8, v10
    v_lshl_add_u32 v10, v12, 3, v10
    v_add_u32 v10, s23, v10
    v_add_u32 v11, 512, v10
    v_bfe_u32 v3, v7, 2, 2
    v_mul_u32_u24 v14, 1056, v3
    v_lshl_add_u32 v14, v9, 8, v14
    v_lshl_add_u32 v14, v12, 3, v14
    v_add_u32 v14, s23, v14
    v_add_u32 v15, 4224, v14
    s_mul_i32 s31, s34, 0x5556
    s_lshr_b32 s31, s31, 16
    s_mul_i32 s31, s31, 3
    s_sub_u32 s31, s34, s31
    s_mul_i32 s30, s34, 10240
    s_lshl_b32 s35, s35, 3
    s_add_u32 s37, s35, 0
    s_mul_i32 s38, s37, 0xcccd
    s_lshr_b32 s38, s38, 18
    s_mul_i32 s38, s38, 240640
    s_lshl_b32 s37, s37, 10
    s_add_u32 s37, s37, s38
    s_add_u32 s44, s37, s30
    s_add_u32 s37, s35, 1
    s_mul_i32 s38, s37, 0xcccd
    s_lshr_b32 s38, s38, 18
    s_mul_i32 s38, s38, 240640
    s_lshl_b32 s37, s37, 10
    s_add_u32 s37, s37, s38
    s_add_u32 s45, s37, s30
    s_add_u32 s37, s35, 2
    s_mul_i32 s38, s37, 0xcccd
    s_lshr_b32 s38, s38, 18
    s_mul_i32 s38, s38, 240640
    s_lshl_b32 s37, s37, 10
    s_add_u32 s37, s37, s38
    s_add_u32 s46, s37, s30
    s_add_u32 s37, s35, 3
    s_mul_i32 s38, s37, 0xcccd
    s_lshr_b32 s38, s38, 18
    s_mul_i32 s38, s38, 240640
    s_lshl_b32 s37, s37, 10
    s_add_u32 s37, s37, s38
    s_add_u32 s47, s37, s30
    s_add_u32 s37, s35, 4
    s_mul_i32 s38, s37, 0xcccd
    s_lshr_b32 s38, s38, 18
    s_mul_i32 s38, s38, 240640
    s_lshl_b32 s37, s37, 10
    s_add_u32 s37, s37, s38
    s_add_u32 s48, s37, s30
    s_add_u32 s37, s35, 5
    s_mul_i32 s38, s37, 0xcccd
    s_lshr_b32 s38, s38, 18
    s_mul_i32 s38, s38, 240640
    s_lshl_b32 s37, s37, 10
    s_add_u32 s37, s37, s38
    s_add_u32 s49, s37, s30
    s_add_u32 s37, s35, 6
    s_mul_i32 s38, s37, 0xcccd
    s_lshr_b32 s38, s38, 18
    s_mul_i32 s38, s38, 240640
    s_lshl_b32 s37, s37, 10
    s_add_u32 s37, s37, s38
    s_add_u32 s50, s37, s30
    s_add_u32 s37, s35, 7
    s_mul_i32 s38, s37, 0xcccd
    s_lshr_b32 s38, s38, 18
    s_mul_i32 s38, s38, 240640
    s_lshl_b32 s37, s37, 10
    s_add_u32 s37, s37, s38
    s_add_u32 s51, s37, s30
    s_barrier
    s_cmp_ge_u32 s21, 15
    s_cbranch_scc1 K1_MISC
    s_add_u32 m0, s23, 0
    s_add_u32 s37, s36, 0
    buffer_load_dwordx4 v8, s[8:11], s37 offen  lds
    s_add_u32 m0, s23, 1056
    s_add_u32 s37, s36, 1280
    buffer_load_dwordx4 v8, s[8:11], s37 offen  lds
    s_add_u32 m0, s23, 2112
    s_add_u32 s37, s36, 2560
    buffer_load_dwordx4 v8, s[8:11], s37 offen  lds
    s_add_u32 m0, s23, 3168
    s_add_u32 s37, s36, 3840
    buffer_load_dwordx4 v8, s[8:11], s37 offen  lds
    s_add_u32 m0, s23, 4224
    s_add_u32 s37, s36, 5120
    buffer_load_dwordx4 v8, s[8:11], s37 offen  lds
    s_add_u32 m0, s23, 5280
    s_add_u32 s37, s36, 6400
    buffer_load_dwordx4 v8, s[8:11], s37 offen  lds
    s_add_u32 m0, s23, 6336
    s_add_u32 s37, s36, 7680
    buffer_load_dwordx4 v8, s[8:11], s37 offen  lds
    s_add_u32 m0, s23, 7392
    s_add_u32 s37, s36, 8960
    buffer_load_dwordx4 v8, s[8:11], s37 offen  lds
    s_cmp_eq_u32 s31, 2
    s_cselect_b64 s[32:33], -1, 0
    v_cndmask_b32 v4, v10, v14, s[32:33]
    v_cndmask_b32 v5, v11, v15, s[32:33]
    s_waitcnt vmcnt(0)
    ds_read_b64_tr_b16 v[16:17], v4 offset:0
    ds_read_b64_tr_b16 v[18:19], v5 offset:0
    ds_read_b64_tr_b16 v[20:21], v4 offset:32
    ds_read_b64_tr_b16 v[22:23], v5 offset:32
    ds_read_b64_tr_b16 v[24:25], v4 offset:64
    ds_read_b64_tr_b16 v[26:27], v5 offset:64
    ds_read_b64_tr_b16 v[28:29], v4 offset:96
    ds_read_b64_tr_b16 v[30:31], v5 offset:96
    ds_read_b64_tr_b16 v[32:33], v4 offset:128
    ds_read_b64_tr_b16 v[34:35], v5 offset:128
    ds_read_b64_tr_b16 v[36:37], v4 offset:160
    ds_read_b64_tr_b16 v[38:39], v5 offset:160
    ds_read_b64_tr_b16 v[40:41], v4 offset:192
    ds_read_b64_tr_b16 v[42:43], v5 offset:192
    ds_read_b64_tr_b16 v[44:45], v4 offset:224
    ds_read_b64_tr_b16 v[46:47], v5 offset:224
    s_waitcnt lgkmcnt(0)
    s_add_u32 m0, s23, 0
    s_add_u32 s37, s36, 40960
    buffer_load_dwordx4 v8, s[8:11], s37 offen  lds
    s_add_u32 m0, s23, 1056
    s_add_u32 s37, s36, 42240
    buffer_load_dwordx4 v8, s[8:11], s37 offen  lds
    s_add_u32 m0, s23, 2112
    s_add_u32 s37, s36, 43520
    buffer_load_dwordx4 v8, s[8:11], s37 offen  lds
    s_add_u32 m0, s23, 3168
    s_add_u32 s37, s36, 44800
    buffer_load_dwordx4 v8, s[8:11], s37 offen  lds
    s_add_u32 m0, s23, 4224
    s_add_u32 s37, s36, 46080
    buffer_load_dwordx4 v8, s[8:11], s37 offen  lds
    s_add_u32 m0, s23, 5280
    s_add_u32 s37, s36, 47360
    buffer_load_dwordx4 v8, s[8:11], s37 offen  lds
    s_add_u32 m0, s23, 6336
    s_add_u32 s37, s36, 48640
    buffer_load_dwordx4 v8, s[8:11], s37 offen  lds
    s_add_u32 m0, s23, 7392
    s_add_u32 s37, s36, 49920
    buffer_load_dwordx4 v8, s[8:11], s37 offen  lds
    s_cmp_eq_u32 s31, 0
    s_cselect_b64 s[32:33], -1, 0
    v_cndmask_b32 v4, v10, v14, s[32:33]
    v_cndmask_b32 v5, v11, v15, s[32:33]
    s_waitcnt vmcnt(0)
    ds_read_b64_tr_b16 v[76:77], v4 offset:0
    ds_read_b64_tr_b16 v[78:79], v5 offset:0
    ds_read_b64_tr_b16 v[80:81], v4 offset:32
    ds_read_b64_tr_b16 v[82:83], v5 offset:32
    ds_read_b64_tr_b16 v[84:85], v4 offset:64
    ds_read_b64_tr_b16 v[86:87], v5 offset:64
    ds_read_b64_tr_b16 v[88:89], v4 offset:96
    ds_read_b64_tr_b16 v[90:91], v5 offset:96
    ds_read_b64_tr_b16 v[92:93], v4 offset:128
    ds_read_b64_tr_b16 v[94:95], v5 offset:128
    ds_read_b64_tr_b16 v[96:97], v4 offset:160
    ds_read_b64_tr_b16 v[98:99], v5 offset:160
    ds_read_b64_tr_b16 v[100:101], v4 offset:192
    ds_read_b64_tr_b16 v[102:103], v5 offset:192
    ds_read_b64_tr_b16 v[104:105], v4 offset:224
    ds_read_b64_tr_b16 v[106:107], v5 offset:224
    s_waitcnt lgkmcnt(0)
    buffer_store_dwordx4 v[16:19], v70, s[40:43], s44 offen sc1
    s_add_u32 s44, s44, 5120
    buffer_store_dwordx4 v[20:23], v70, s[40:43], s45 offen sc1
    s_add_u32 s45, s45, 5120
    buffer_store_dwordx4 v[24:27], v70, s[40:43], s46 offen sc1
    s_add_u32 s46, s46, 5120
    buffer_store_dwordx4 v[28:31], v70, s[40:43], s47 offen sc1
    s_add_u32 s47, s47, 5120
    buffer_store_dwordx4 v[32:35], v70, s[40:43], s48 offen sc1
    s_add_u32 s48, s48, 5120
    buffer_store_dwordx4 v[36:39], v70, s[40:43], s49 offen sc1
    s_add_u32 s49, s49, 5120
    buffer_store_dwordx4 v[40:43], v70, s[40:43], s50 offen sc1
    s_add_u32 s50, s50, 5120
    buffer_store_dwordx4 v[44:47], v70, s[40:43], s51 offen sc1
    s_add_u32 s51, s51, 5120
    buffer_store_dwordx4 v[76:79], v70, s[40:43], s44 offen sc1
    buffer_store_dwordx4 v[80:83], v70, s[40:43], s45 offen sc1
    buffer_store_dwordx4 v[84:87], v70, s[40:43], s46 offen sc1
    buffer_store_dwordx4 v[88:91], v70, s[40:43], s47 offen sc1
    buffer_store_dwordx4 v[92:95], v70, s[40:43], s48 offen sc1
    buffer_store_dwordx4 v[96:99], v70, s[40:43], s49 offen sc1
    buffer_store_dwordx4 v[100:103], v70, s[40:43], s50 offen sc1
    buffer_store_dwordx4 v[104:107], v70, s[40:43], s51 offen sc1
    s_branch K1_LNEND
K1_MISC:
    s_add_u32 s12, s54, 0x1100000
    s_addc_u32 s13, s55, 0
    s_mov_b32 s14, 0x28000
    s_mov_b32 s15, 0x20000
    s_and_b32 s23, s2, 7
    s_mul_i32 s23, s23, 20480
    v_lshlrev_b32 v3, 7, v7
    buffer_store_dword v72, v3, s[12:15], s23 offen
    s_add_u32 s23, s23, 8192
    buffer_store_dword v72, v3, s[12:15], s23 offen
    s_add_u32 s23, s23, 8192
    buffer_store_dword v72, v3, s[12:15], s23 offen
    s_add_u32 s23, s23, 8192
    s_branch K1_LNEND
K1_KGEN:
    s_setprio 2
    s_load_dwordx8 s[4:11], s[0:1], 8
    s_load_dwordx8 s[12:19], s[0:1], 40
    s_load_dwordx4 s[52:55], s[0:1], 112
    s_sub_u32 s20, s2, 128
    s_and_b32 s3, s20, 7
    s_mul_i32 s3, s3, 80
    s_lshr_b32 s21, s20, 3
    s_add_u32 s3, s3, s21
    v_lshrrev_b32 v1, 6, v0
    v_lshlrev_b32 v2, 1, v0
    v_readfirstlane_b32 s22, v1
    s_mul_i32 s23, s3, 384
    s_lshl_b32 s24, s3, 1
    s_and_b32 s24, s24, 0xfffffffc
    v_and_b32 v4, 63, v0
    v_lshlrev_b32 v7, 1, v4
    v_mov_b32 v8, 0
    v_mov_b32 v9, 0
    v_mov_b32 v10, 0
    v_mov_b32 v11, 0
    v_mov_b32 v12, 0
    v_mov_b32 v13, 0
    v_lshlrev_b32 v14, 3, v0
    v_cvt_f32_u32 v15, v14
    v_add_f32 v136, 0xc0400000, v15
    v_add_f32 v137, 0xc0000000, v15
    v_add_f32 v138, 0xbf800000, v15
    v_add_f32 v139, 0x00000000, v15
    v_add_f32 v140, 0x3f800000, v15
    v_add_f32 v141, 0x40000000, v15
    v_add_f32 v142, 0x40400000, v15
    v_add_f32 v143, 0x40800000, v15
    v_add_f32 v144, 0x40a00000, v15
    v_add_f32 v145, 0x40c00000, v15
    v_add_f32 v146, 0x40e00000, v15
    v_cvt_pk_bf16_f32 v136, v136, v136
    v_cvt_pk_bf16_f32 v137, v137, v137
    v_cvt_pk_bf16_f32 v138, v138, v138
    v_cvt_pk_bf16_f32 v139, v139, v139
    v_cvt_pk_bf16_f32 v140, v140, v140
    v_cvt_pk_bf16_f32 v141, v141, v141
    v_cvt_pk_bf16_f32 v142, v142, v142
    v_cvt_pk_bf16_f32 v143, v143, v143
    v_cvt_pk_bf16_f32 v144, v144, v144
    v_cvt_pk_bf16_f32 v145, v145, v145
    v_cvt_pk_bf16_f32 v146, v146, v146
    s_waitcnt lgkmcnt(0)
    s_lshl_b32 s27, s22, 16
    s_add_u32 s27, s27, s2
    s_cmp_lg_u32 s27, 196737
    s_cbranch_scc1 K1_NOINIT
    s_add_u32 s64, s54, 0x10c0000
    s_addc_u32 s65, s55, 0
    s_mov_b32 s66, 0xa000
    s_mov_b32 s67, 0x20000
    s_mov_b32 s68, s52
    s_mov_b32 s69, s53
    s_mov_b32 s70, 0x100
    s_mov_b32 s71, 0x20000
    v_lshlrev_b32 v20, 7, v4
    v_mov_b32 v21, 0
    v_mov_b32 v22, 1
    s_mov_b32 s27, 0x4000
    buffer_store_dword v21, v20, s[64:67], s27 offen sc1
    s_mov_b32 s27, 0x6000
    buffer_store_dword v21, v20, s[64:67], s27 offen sc1
    s_mov_b32 s27, 0x8000
    buffer_store_dword v21, v20, s[64:67], s27 offen sc1
    s_waitcnt vmcnt(0)
    s_mov_b64 exec, 1
    buffer_store_dword v22, v21, s[68:71], 0 offen sc1
    s_mov_b64 exec, -1
K1_NOINIT:
    s_load_dword s25, s[16:17], s24
    s_load_dword s26, s[18:19], s24
    s_mov_b32 s28, s4
    s_mov_b32 s29, s5
    s_mov_b32 s30, 0x3c000
    s_mov_b32 s31, 0x20000
    s_mov_b32 s32, s6
    s_mov_b32 s33, s7
    s_mov_b32 s34, 0x3c000
    s_mov_b32 s35, 0x20000
    s_cmp_eq_u32 s22, 3
    s_cbranch_scc1 K1_LDQ
    buffer_load_short_d16_hi v8, v2, s[28:31], s23 offen
    buffer_load_short_d16_hi v9, v2, s[32:35], s23 offen
    s_mov_b32 s36, s8
    s_mov_b32 s37, s9
    s_mov_b32 s38, 0x3c000
    s_mov_b32 s39, 0x20000
    buffer_load_short_d16_hi v10, v2, s[36:39], s23 offen
    s_mov_b32 s40, s10
    s_mov_b32 s41, s11
    s_mov_b32 s42, 0x3c000
    s_mov_b32 s43, 0x20000
    buffer_load_short_d16_hi v11, v2, s[40:43], s23 offen
    s_mov_b32 s44, s12
    s_mov_b32 s45, s13
    s_mov_b32 s46, 0x3c000
    s_mov_b32 s47, 0x20000
    buffer_load_short_d16_hi v12, v2, s[44:47], s23 offen
    s_mov_b32 s48, s14
    s_mov_b32 s49, s15
    s_mov_b32 s50, 0x3c000
    s_mov_b32 s51, 0x20000
    buffer_load_short_d16_hi v13, v2, s[48:51], s23 offen
    s_branch K1_LDD
K1_LDQ:
    buffer_load_short_d16_hi v8, v7, s[28:31], s23 offen offset:0
    buffer_load_short_d16_hi v9, v7, s[32:35], s23 offen offset:0
    buffer_load_short_d16_hi v10, v7, s[28:31], s23 offen offset:128
    buffer_load_short_d16_hi v11, v7, s[32:35], s23 offen offset:128
    buffer_load_short_d16_hi v12, v7, s[28:31], s23 offen offset:256
    buffer_load_short_d16_hi v13, v7, s[32:35], s23 offen offset:256
    s_load_dwordx4 s[4:7], s[0:1], 80
    s_load_dwordx2 s[8:9], s[0:1], 96
K1_LDD:
    s_mov_b32 s56, s54
    s_mov_b32 s57, s55
    s_mov_b32 s58, 0x500000
    s_mov_b32 s59, 0x20000
    s_add_u32 s60, s54, 0x780000
    s_addc_u32 s61, s55, 0
    s_mov_b32 s62, 0x280000
    s_mov_b32 s63, 0x20000
    s_mov_b32 s68, s52
    s_mov_b32 s69, s53
    s_mov_b32 s70, 0x100
    s_mov_b32 s71, 0x20000
    s_add_u32 s64, s54, 0x10c0000
    s_addc_u32 s65, s55, 0
    s_mov_b32 s66, 0xa000
    s_mov_b32 s67, 0x20000
    v_bfe_u32 v136, v136, 14, 13
    v_bfe_u32 v137, v137, 14, 13
    v_bfe_u32 v138, v138, 14, 13
    v_bfe_u32 v139, v139, 14, 13
    v_bfe_u32 v140, v140, 14, 13
    v_bfe_u32 v141, v141, 14, 13
    v_bfe_u32 v142, v142, 14, 13
    v_bfe_u32 v143, v143, 14, 13
    v_bfe_u32 v144, v144, 14, 13
    v_bfe_u32 v145, v145, 14, 13
    v_bfe_u32 v146, v146, 14, 13
    v_mov_b32 v152, 0
    v_cmp_eq_u32 s[72:73], 0, v0
    s_cmp_lg_u32 s22, 0
    s_cbranch_scc1 K1_NOFIX
    v_lshlrev_b32 v15, 2, v14
    v_add_u32 v16, 2549, v15
    v_cmp_gt_i32 vcc, 131, v14
    s_nop 1
    v_cndmask_b32 v136, v136, v16, vcc
    v_add_u32 v16, 2553, v15
    v_cmp_gt_i32 vcc, 130, v14
    s_nop 1
    v_cndmask_b32 v137, v137, v16, vcc
    v_add_u32 v16, 2557, v15
    v_cmp_gt_i32 vcc, 129, v14
    s_nop 1
    v_cndmask_b32 v138, v138, v16, vcc
    v_add_u32 v16, 2561, v15
    v_cmp_gt_i32 vcc, 128, v14
    s_nop 1
    v_cndmask_b32 v139, v139, v16, vcc
    v_add_u32 v16, 2565, v15
    v_cmp_gt_i32 vcc, 127, v14
    s_nop 1
    v_cndmask_b32 v140, v140, v16, vcc
    v_add_u32 v16, 2569, v15
    v_cmp_gt_i32 vcc, 126, v14
    s_nop 1
    v_cndmask_b32 v141, v141, v16, vcc
    v_add_u32 v16, 2573, v15
    v_cmp_gt_i32 vcc, 125, v14
    s_nop 1
    v_cndmask_b32 v142, v142, v16, vcc
    v_add_u32 v16, 2577, v15
    v_cmp_gt_i32 vcc, 124, v14
    s_nop 1
    v_cndmask_b32 v143, v143, v16, vcc
    v_add_u32 v16, 2581, v15
    v_cmp_gt_i32 vcc, 123, v14
    s_nop 1
    v_cndmask_b32 v144, v144, v16, vcc
    v_add_u32 v16, 2585, v15
    v_cmp_gt_i32 vcc, 122, v14
    s_nop 1
    v_cndmask_b32 v145, v145, v16, vcc
    v_add_u32 v16, 2589, v15
    v_cmp_gt_i32 vcc, 121, v14
    s_nop 1
    v_cndmask_b32 v146, v146, v16, vcc
    v_mov_b32 v16, 5633
    v_cndmask_b32 v136, v136, v16, s[72:73]
    v_cndmask_b32 v137, v137, v16, s[72:73]
    v_cndmask_b32 v138, v138, v16, s[72:73]
    ds_write_b32 v152, v152 offset:53248
K1_NOFIX:
    v_and_b32 v17, 1, v0
    v_and_b32 v5, 15, v0
    v_bfe_u32 v6, v0, 4, 2
    v_mul_u32_u24 v108, 800, v5
    v_lshl_add_u32 v108, v6, 4, v108
    s_mul_i32 s27, s22, 12800
    s_add_u32 s27, s27, 12800
    v_add_u32 v109, s27, v108
    v_lshlrev_b32 v110, 6, v5
    v_lshl_add_u32 v110, v6, 4, v110
    v_add_u32 v111, 8, v110
    s_cmp_eq_u32 s22, 0
    s_cbranch_scc1 K1_GA
    v_lshlrev_b32 v110, 3, v5
    v_lshl_add_u32 v110, v6, 8, v110
    v_add_u32 v110, 2048, v110
    v_add_u32 v111, 128, v110
    s_cmp_lg_u32 s22, 1
    s_cbranch_scc1 K1_GA
    v_lshlrev_b32 v110, 5, v5
    v_lshl_add_u32 v110, v6, 4, v110
    v_lshlrev_b32 v111, 4, v5
    v_lshl_add_u32 v111, v6, 8, v111
    v_cmp_gt_u32 vcc, 2, v6
    s_nop 1
    v_cndmask_b32 v110, v111, v110, vcc
    v_add_u32 v110, 1024, v110
    v_add_u32 v111, 8, v110
K1_GA:
    v_lshlrev_b32 v112, 4, v0
    v_lshlrev_b32 v151, 4, v4
    v_lshrrev_b32 v16, 1, v0
    v_lshlrev_b32 v153, 7, v16
    v_mul_u32_u24 v155, 20480, v16
    v_lshl_add_u32 v155, v17, 4, v155
    v_mul_u32_u24 v154, 2304, v17
    v_lshl_add_u32 v154, v16, 3, v154
    v_and_b32 v18, 3, v0
    v_bfe_u32 v19, v0, 2, 2
    v_sub_u32 v19, v18, v19
    v_lshlrev_b32 v20, 3, v6
    v_sub_u32 v19, v19, v20
    s_mul_i32 s74, s22, 4128
    s_add_u32 s75, s74, 224
    v_lshl_add_u32 v147, v19, 3, s75
    v_add_u32 v162, s74, v151
    v_lshl_add_u32 v166, v18, 3, s74
    v_lshl_add_u32 v19, v6, 1, v5
    s_mul_i32 s74, s22, 1152
    s_add_u32 s75, s74, 16520
    v_lshl_add_u32 v148, v19, 3, s75
    v_xor_b32 v19, 1, v17
    v_mul_u32_u24 v19, 4744, v19
    v_add_u32 v148, v148, v19
    v_bfe_u32 v19, v0, 4, 1
    v_mul_u32_u24 v19, 4744, v19
    v_lshl_add_u32 v19, v5, 3, v19
    v_add_u32 v167, s74, v19
    v_lshlrev_b32 v149, 5, v0
    v_lshlrev_b32 v157, 2, v0
    v_lshrrev_b32 v20, 4, v0
    v_mul_u32_u24 v150, 163840, v20
    v_lshl_add_u32 v150, v5, 4, v150
    v_lshlrev_b32 v20, 9, v17
    v_bfe_u32 v19, v0, 1, 4
    v_lshl_add_u32 v20, v19, 4, v20
    v_bfe_u32 v18, v0, 5, 2
    v_lshl_add_u32 v20, v18, 10, v20
    s_cmp_lt_u32 s22, 2
    s_cselect_b32 s74, 25840, 0
    v_add_u32 v163, s74, v20
    s_waitcnt lgkmcnt(0)
    s_bitcmp1_b32 s3, 0
    s_cselect_b32 s24, 0, 16
    s_lshl_b32 s25, s25, s24
    s_and_b32 s25, s25, 0xffff0000
    s_lshl_b32 s26, s26, s24
    s_and_b32 s26, s26, 0xffff0000
    v_mov_b32 v5, s26
    v_cndmask_b32 v113, 0, v5, s[72:73]
    v_mov_b32 v5, 0x3fb8aa3b
    v_mul_f32 v5, s25, v5
    v_exp_f32 v5, v5
    s_nop 0
    v_cvt_pk_bf16_f32 v5, v5, v5
    v_and_b32 v5, 0xffff0000, v5
    v_mul_f32 v6, 0x3fb8aa3b, v5
    v_mul_f32 v7, 0x3e22f983, v5
    v_mul_f32 v16, 0x43800000, v6
    v_mul_f32 v17, 0x43800000, v7
    v_mul_f32 v18, 0x41800000, v6
    v_mul_f32 v19, 0xc1800000, v7
    s_waitcnt vmcnt(0)
    s_mov_b32 s33, 0x4000
    s_lshl_b32 s30, s3, 5
    s_lshl_b32 s29, s3, 8
    s_mov_b32 s75, 0x2000
    s_cmp_eq_u32 s22, 3
    s_cbranch_scc1 K1_Q
    s_waitcnt vmcnt(0)
    v_mul_f32 v10, v5, v10
    v_mul_f32 v11, v5, v11
    s_lshl_b32 m0, s22, 8
    v_pk_mul_f32 v[32:33], v[10:11], v[12:13] op_sel:[0,0] op_sel_hi:[0,1]
    v_pk_fma_f32 v[32:33], v[10:11], v[12:13], v[32:33] op_sel:[1,1,0] op_sel_hi:[1,0,1] neg_lo:[0,1,0]
    v_mul_f32 v20, v6, v8
    v_mul_f32 v21, v7, v9
    v_mul_f32 v23, v16, v8
    v_mul_f32 v24, v17, v9
    v_fract_f32 v21, v21
    v_fract_f32 v24, v24
    v_exp_f32 v20, v20
    v_cos_f32 v22, v21
    v_sin_f32 v21, v21
    v_exp_f32 v23, v23
    v_cos_f32 v25, v24
    v_sin_f32 v24, v24
    v_mul_f32 v14, v20, v22
    v_mul_f32 v15, v20, v21
    v_mul_f32 v18, v23, v25
    v_mul_f32 v19, v23, v24
    v_cvt_pk_bf16_f32 v96, v32, v33
    v_pk_mul_f32 v[64:65], v[32:33], v[18:19] op_sel:[0,0] op_sel_hi:[0,1]
    ds_write_addtid_b32 v96 offset:12800
    v_pk_fma_f32 v[64:65], v[32:33], v[18:19], v[64:65] op_sel:[1,1,0] op_sel_hi:[1,0,1] neg_lo:[0,1,0]
    v_pk_mul_f32 v[34:35], v[32:33], v[14:15] op_sel:[0,0] op_sel_hi:[0,1]
    v_cvt_pk_bf16_f32 v97, v64, v65
    v_pk_fma_f32 v[34:35], v[32:33], v[14:15], v[34:35] op_sel:[1,1,0] op_sel_hi:[1,0,1] neg_lo:[0,1,0]
    ds_write_addtid_b32 v97 offset:25600
    v_pk_mul_f32 v[80:81], v[64:65], v[18:19] op_sel:[0,0] op_sel_hi:[0,1]
    v_cvt_pk_bf16_f32 v98, v34, v35
    v_pk_fma_f32 v[80:81], v[64:65], v[18:19], v[80:81] op_sel:[1,1,0] op_sel_hi:[1,0,1] neg_lo:[0,1,0]
    ds_write_addtid_b32 v98 offset:13600
    v_pk_mul_f32 v[36:37], v[34:35], v[14:15] op_sel:[0,0] op_sel_hi:[0,1]
    v_cvt_pk_bf16_f32 v99, v80, v81
    v_pk_fma_f32 v[36:37], v[34:35], v[14:15], v[36:37] op_sel:[1,1,0] op_sel_hi:[1,0,1] neg_lo:[0,1,0]
    ds_write_addtid_b32 v99 offset:32000
    v_pk_mul_f32 v[88:89], v[80:81], v[18:19] op_sel:[0,0] op_sel_hi:[0,1]
    v_cvt_pk_bf16_f32 v100, v36, v37
    v_pk_fma_f32 v[88:89], v[80:81], v[18:19], v[88:89] op_sel:[1,1,0] op_sel_hi:[1,0,1] neg_lo:[0,1,0]
    ds_write_addtid_b32 v100 offset:14400
    v_pk_mul_f32 v[66:67], v[36:37], v[18:19] op_sel:[0,0] op_sel_hi:[0,1]
    v_cvt_pk_bf16_f32 v101, v88, v89
    v_pk_fma_f32 v[66:67], v[36:37], v[18:19], v[66:67] op_sel:[1,1,0] op_sel_hi:[1,0,1] neg_lo:[0,1,0]
    ds_write_addtid_b32 v101 offset:35200
    v_pk_mul_f32 v[38:39], v[36:37], v[14:15] op_sel:[0,0] op_sel_hi:[0,1]
    v_cvt_pk_bf16_f32 v102, v66, v67
    v_pk_fma_f32 v[38:39], v[36:37], v[14:15], v[38:39] op_sel:[1,1,0] op_sel_hi:[1,0,1] neg_lo:[0,1,0]
    ds_write_addtid_b32 v102 offset:26400
    v_pk_mul_f32 v[114:115], v[88:89], v[18:19] op_sel:[0,0] op_sel_hi:[0,1]
    v_cvt_pk_bf16_f32 v103, v38, v39
    v_pk_fma_f32 v[114:115], v[88:89], v[18:19], v[114:115] op_sel:[1,1,0] op_sel_hi:[1,0,1] neg_lo:[0,1,0]
    ds_write_addtid_b32 v103 offset:15200
    v_pk_mul_f32 v[40:41], v[38:39], v[14:15] op_sel:[0,0] op_sel_hi:[0,1]
    v_cvt_pk_bf16_f32 v96, v114, v115
    v_pk_fma_f32 v[40:41], v[38:39], v[14:15], v[40:41] op_sel:[1,1,0] op_sel_hi:[1,0,1] neg_lo:[0,1,0]
    ds_write_addtid_b32 v96 offset:38400
    v_pk_mul_f32 v[118:119], v[114:115], v[18:19] op_sel:[0,0] op_sel_hi:[0,1]
    v_cvt_pk_bf16_f32 v97, v40, v41
    v_pk_fma_f32 v[118:119], v[114:115], v[18:19], v[118:119] op_sel:[1,1,0] op_sel_hi:[1,0,1] neg_lo:[0,1,0]
    ds_write_addtid_b32 v97 offset:16000
    v_pk_mul_f32 v[68:69], v[40:41], v[18:19] op_sel:[0,0] op_sel_hi:[0,1]
    v_cvt_pk_bf16_f32 v98, v118, v119
    v_pk_fma_f32 v[68:69], v[40:41], v[18:19], v[68:69] op_sel:[1,1,0] op_sel_hi:[1,0,1] neg_lo:[0,1,0]
    ds_write_addtid_b32 v98 offset:40000
    v_pk_mul_f32 v[42:43], v[40:41], v[14:15] op_sel:[0,0] op_sel_hi:[0,1]
    v_cvt_pk_bf16_f32 v99, v68, v69
    v_pk_fma_f32 v[42:43], v[40:41], v[14:15], v[42:43] op_sel:[1,1,0] op_sel_hi:[1,0,1] neg_lo:[0,1,0]
    ds_write_addtid_b32 v99 offset:27200
    v_pk_mul_f32 v[82:83], v[68:69], v[18:19] op_sel:[0,0] op_sel_hi:[0,1]
    v_cvt_pk_bf16_f32 v100, v42, v43
    v_pk_fma_f32 v[82:83], v[68:69], v[18:19], v[82:83] op_sel:[1,1,0] op_sel_hi:[1,0,1] neg_lo:[0,1,0]
    ds_write_addtid_b32 v100 offset:16800
    v_pk_mul_f32 v[122:123], v[118:119], v[18:19] op_sel:[0,0] op_sel_hi:[0,1]
    v_cvt_pk_bf16_f32 v101, v82, v83
    v_pk_fma_f32 v[122:123], v[118:119], v[18:19], v[122:123] op_sel:[1,1,0] op_sel_hi:[1,0,1] neg_lo:[0,1,0]
    ds_write_addtid_b32 v101 offset:32800
    v_pk_mul_f32 v[44:45], v[42:43], v[14:15] op_sel:[0,0] op_sel_hi:[0,1]
    v_cvt_pk_bf16_f32 v102, v122, v123
    v_pk_fma_f32 v[44:45], v[42:43], v[14:15], v[44:45] op_sel:[1,1,0] op_sel_hi:[1,0,1] neg_lo:[0,1,0]
    ds_write_addtid_b32 v102 offset:41600
    v_pk_mul_f32 v[90:91], v[82:83], v[18:19] op_sel:[0,0] op_sel_hi:[0,1]
    v_cvt_pk_bf16_f32 v103, v44, v45
    v_pk_fma_f32 v[90:91], v[82:83], v[18:19], v[90:91] op_sel:[1,1,0] op_sel_hi:[1,0,1] neg_lo:[0,1,0]
    ds_write_addtid_b32 v103 offset:17600
    v_pk_mul_f32 v[126:127], v[122:123], v[18:19] op_sel:[0,0] op_sel_hi:[0,1]
    v_cvt_pk_bf16_f32 v96, v90, v91
    v_pk_fma_f32 v[126:127], v[122:123], v[18:19], v[126:127] op_sel:[1,1,0] op_sel_hi:[1,0,1] neg_lo:[0,1,0]
    ds_write_addtid_b32 v96 offset:36000
    v_pk_mul_f32 v[70:71], v[44:45], v[18:19] op_sel:[0,0] op_sel_hi:[0,1]
    v_cvt_pk_bf16_f32 v97, v126, v127
    v_pk_fma_f32 v[70:71], v[44:45], v[18:19], v[70:71] op_sel:[1,1,0] op_sel_hi:[1,0,1] neg_lo:[0,1,0]
    ds_write_addtid_b32 v97 offset:43200
    v_pk_mul_f32 v[46:47], v[44:45], v[14:15] op_sel:[0,0] op_sel_hi:[0,1]
    v_cvt_pk_bf16_f32 v98, v70, v71
    v_pk_fma_f32 v[46:47], v[44:45], v[14:15], v[46:47] op_sel:[1,1,0] op_sel_hi:[1,0,1] neg_lo:[0,1,0]
    ds_write_addtid_b32 v98 offset:28000
    v_pk_mul_f32 v[130:131], v[126:127], v[18:19] op_sel:[0,0] op_sel_hi:[0,1]
    v_cvt_pk_bf16_f32 v99, v46, v47
    v_pk_fma_f32 v[130:131], v[126:127], v[18:19], v[130:131] op_sel:[1,1,0] op_sel_hi:[1,0,1] neg_lo:[0,1,0]
    ds_write_addtid_b32 v99 offset:18400
    v_pk_mul_f32 v[48:49], v[46:47], v[14:15] op_sel:[0,0] op_sel_hi:[0,1]
    v_cvt_pk_bf16_f32 v100, v130, v131
    v_pk_fma_f32 v[48:49], v[46:47], v[14:15], v[48:49] op_sel:[1,1,0] op_sel_hi:[1,0,1] neg_lo:[0,1,0]
    ds_write_addtid_b32 v100 offset:44800
    v_cvt_pk_bf16_f32 v101, v48, v49
    v_pk_mul_f32 v[72:73], v[48:49], v[18:19] op_sel:[0,0] op_sel_hi:[0,1]
    ds_write_addtid_b32 v101 offset:19200
    v_pk_fma_f32 v[72:73], v[48:49], v[18:19], v[72:73] op_sel:[1,1,0] op_sel_hi:[1,0,1] neg_lo:[0,1,0]
    v_pk_mul_f32 v[50:51], v[48:49], v[14:15] op_sel:[0,0] op_sel_hi:[0,1]
    v_cvt_pk_bf16_f32 v102, v72, v73
    v_pk_fma_f32 v[50:51], v[48:49], v[14:15], v[50:51] op_sel:[1,1,0] op_sel_hi:[1,0,1] neg_lo:[0,1,0]
    ds_write_addtid_b32 v102 offset:28800
    v_pk_mul_f32 v[84:85], v[72:73], v[18:19] op_sel:[0,0] op_sel_hi:[0,1]
    v_cvt_pk_bf16_f32 v103, v50, v51
    v_pk_fma_f32 v[84:85], v[72:73], v[18:19], v[84:85] op_sel:[1,1,0] op_sel_hi:[1,0,1] neg_lo:[0,1,0]
    ds_write_addtid_b32 v103 offset:20000
    v_pk_mul_f32 v[52:53], v[50:51], v[14:15] op_sel:[0,0] op_sel_hi:[0,1]
    v_cvt_pk_bf16_f32 v96, v84, v85
    v_pk_fma_f32 v[52:53], v[50:51], v[14:15], v[52:53] op_sel:[1,1,0] op_sel_hi:[1,0,1] neg_lo:[0,1,0]
    ds_write_addtid_b32 v96 offset:33600
    v_pk_mul_f32 v[92:93], v[84:85], v[18:19] op_sel:[0,0] op_sel_hi:[0,1]
    v_cvt_pk_bf16_f32 v97, v52, v53
    v_pk_fma_f32 v[92:93], v[84:85], v[18:19], v[92:93] op_sel:[1,1,0] op_sel_hi:[1,0,1] neg_lo:[0,1,0]
    ds_write_addtid_b32 v97 offset:20800
    v_pk_mul_f32 v[74:75], v[52:53], v[18:19] op_sel:[0,0] op_sel_hi:[0,1]
    v_cvt_pk_bf16_f32 v98, v92, v93
    v_pk_fma_f32 v[74:75], v[52:53], v[18:19], v[74:75] op_sel:[1,1,0] op_sel_hi:[1,0,1] neg_lo:[0,1,0]
    ds_write_addtid_b32 v98 offset:36800
    v_pk_mul_f32 v[54:55], v[52:53], v[14:15] op_sel:[0,0] op_sel_hi:[0,1]
    v_cvt_pk_bf16_f32 v99, v74, v75
    v_pk_fma_f32 v[54:55], v[52:53], v[14:15], v[54:55] op_sel:[1,1,0] op_sel_hi:[1,0,1] neg_lo:[0,1,0]
    ds_write_addtid_b32 v99 offset:29600
    v_pk_mul_f32 v[116:117], v[92:93], v[18:19] op_sel:[0,0] op_sel_hi:[0,1]
    v_cvt_pk_bf16_f32 v100, v54, v55
    v_pk_fma_f32 v[116:117], v[92:93], v[18:19], v[116:117] op_sel:[1,1,0] op_sel_hi:[1,0,1] neg_lo:[0,1,0]
    ds_write_addtid_b32 v100 offset:21600
    v_pk_mul_f32 v[56:57], v[54:55], v[14:15] op_sel:[0,0] op_sel_hi:[0,1]
    v_cvt_pk_bf16_f32 v101, v116, v117
    v_pk_fma_f32 v[56:57], v[54:55], v[14:15], v[56:57] op_sel:[1,1,0] op_sel_hi:[1,0,1] neg_lo:[0,1,0]
    ds_write_addtid_b32 v101 offset:39200
    v_pk_mul_f32 v[120:121], v[116:117], v[18:19] op_sel:[0,0] op_sel_hi:[0,1]
    v_cvt_pk_bf16_f32 v102, v56, v57
    v_pk_fma_f32 v[120:121], v[116:117], v[18:19], v[120:121] op_sel:[1,1,0] op_sel_hi:[1,0,1] neg_lo:[0,1,0]
    ds_write_addtid_b32 v102 offset:22400
    v_pk_mul_f32 v[76:77], v[56:57], v[18:19] op_sel:[0,0] op_sel_hi:[0,1]
    v_cvt_pk_bf16_f32 v103, v120, v121
    v_pk_fma_f32 v[76:77], v[56:57], v[18:19], v[76:77] op_sel:[1,1,0] op_sel_hi:[1,0,1] neg_lo:[0,1,0]
    ds_write_addtid_b32 v103 offset:40800
    v_pk_mul_f32 v[58:59], v[56:57], v[14:15] op_sel:[0,0] op_sel_hi:[0,1]
    v_cvt_pk_bf16_f32 v96, v76, v77
    v_pk_fma_f32 v[58:59], v[56:57], v[14:15], v[58:59] op_sel:[1,1,0] op_sel_hi:[1,0,1] neg_lo:[0,1,0]
    ds_write_addtid_b32 v96 offset:30400
    v_pk_mul_f32 v[86:87], v[76:77], v[18:19] op_sel:[0,0] op_sel_hi:[0,1]
    v_cvt_pk_bf16_f32 v97, v58, v59
    v_pk_fma_f32 v[86:87], v[76:77], v[18:19], v[86:87] op_sel:[1,1,0] op_sel_hi:[1,0,1] neg_lo:[0,1,0]
    ds_write_addtid_b32 v97 offset:23200
    v_pk_mul_f32 v[124:125], v[120:121], v[18:19] op_sel:[0,0] op_sel_hi:[0,1]
    v_cvt_pk_bf16_f32 v98, v86, v87
    v_pk_fma_f32 v[124:125], v[120:121], v[18:19], v[124:125] op_sel:[1,1,0] op_sel_hi:[1,0,1] neg_lo:[0,1,0]
    ds_write_addtid_b32 v98 offset:34400
    v_pk_mul_f32 v[60:61], v[58:59], v[14:15] op_sel:[0,0] op_sel_hi:[0,1]
    v_cvt_pk_bf16_f32 v99, v124, v125
    v_pk_fma_f32 v[60:61], v[58:59], v[14:15], v[60:61] op_sel:[1,1,0] op_sel_hi:[1,0,1] neg_lo:[0,1,0]
    ds_write_addtid_b32 v99 offset:42400
    v_pk_mul_f32 v[94:95], v[86:87], v[18:19] op_sel:[0,0] op_sel_hi:[0,1]
    v_cvt_pk_bf16_f32 v100, v60, v61
    v_pk_fma_f32 v[94:95], v[86:87], v[18:19], v[94:95] op_sel:[1,1,0] op_sel_hi:[1,0,1] neg_lo:[0,1,0]
    ds_write_addtid_b32 v100 offset:24000
    v_pk_mul_f32 v[128:129], v[124:125], v[18:19] op_sel:[0,0] op_sel_hi:[0,1]
    v_cvt_pk_bf16_f32 v101, v94, v95
    v_pk_fma_f32 v[128:129], v[124:125], v[18:19], v[128:129] op_sel:[1,1,0] op_sel_hi:[1,0,1] neg_lo:[0,1,0]
    ds_write_addtid_b32 v101 offset:37600
    v_pk_mul_f32 v[78:79], v[60:61], v[18:19] op_sel:[0,0] op_sel_hi:[0,1]
    v_cvt_pk_bf16_f32 v102, v128, v129
    v_pk_fma_f32 v[78:79], v[60:61], v[18:19], v[78:79] op_sel:[1,1,0] op_sel_hi:[1,0,1] neg_lo:[0,1,0]
    ds_write_addtid_b32 v102 offset:44000
    v_pk_mul_f32 v[62:63], v[60:61], v[14:15] op_sel:[0,0] op_sel_hi:[0,1]
    v_cvt_pk_bf16_f32 v103, v78, v79
    v_pk_fma_f32 v[62:63], v[60:61], v[14:15], v[62:63] op_sel:[1,1,0] op_sel_hi:[1,0,1] neg_lo:[0,1,0]
    ds_write_addtid_b32 v103 offset:31200
    v_cvt_pk_bf16_f32 v96, v62, v63
    ds_write_addtid_b32 v96 offset:24800
    s_waitcnt lgkmcnt(0)
    s_barrier
    ds_read_b128 v[4:7], v109 offset:0
    ds_read_b128 v[8:11], v108 offset:0
    ds_read_b128 v[12:15], v109 offset:64
    ds_read_b128 v[16:19], v108 offset:64
    ds_read_b128 v[20:23], v109 offset:128
    ds_read_b128 v[24:27], v108 offset:128
    ds_read_b128 v[28:31], v109 offset:192
    ds_read_b128 v[32:35], v108 offset:192
    ds_read_b128 v[36:39], v109 offset:256
    ds_read_b128 v[40:43], v108 offset:256
    ds_read_b128 v[44:47], v109 offset:320
    ds_read_b128 v[48:51], v108 offset:320
    ds_read_b128 v[52:55], v109 offset:384
    ds_read_b128 v[56:59], v108 offset:384
    s_cmp_lt_u32 s2, 640
    s_cbranch_scc1 K1_NEP
    buffer_load_dword v156, v152, s[68:71], 0 offen sc1
K1_NEP:
    s_waitcnt lgkmcnt(12)
    v_mfma_f32_16x16x32_bf16 v[114:117], v[4:7], v[8:11], 0
    ds_read_b128 v[60:63], v109 offset:448
    ds_read_b128 v[64:67], v108 offset:448
    s_waitcnt lgkmcnt(12)
    v_mfma_f32_16x16x32_bf16 v[114:117], v[12:15], v[16:19], v[114:117]
    ds_read_b128 v[68:71], v109 offset:512
    ds_read_b128 v[72:75], v108 offset:512
    s_waitcnt lgkmcnt(12)
    v_mfma_f32_16x16x32_bf16 v[114:117], v[20:23], v[24:27], v[114:117]
    ds_read_b128 v[76:79], v109 offset:576
    ds_read_b128 v[80:83], v108 offset:576
    s_waitcnt lgkmcnt(12)
    v_mfma_f32_16x16x32_bf16 v[114:117], v[28:31], v[32:35], v[114:117]
    ds_read_b128 v[84:87], v109 offset:640
    ds_read_b128 v[88:91], v108 offset:640
    s_waitcnt lgkmcnt(12)
    v_mfma_f32_16x16x32_bf16 v[114:117], v[36:39], v[40:43], v[114:117]
    ds_read_b128 v[92:95], v109 offset:704
    ds_read_b128 v[96:99], v108 offset:704
    s_waitcnt lgkmcnt(12)
    v_mfma_f32_16x16x32_bf16 v[114:117], v[44:47], v[48:51], v[114:117]
    s_waitcnt lgkmcnt(10)
    v_mfma_f32_16x16x32_bf16 v[114:117], v[52:55], v[56:59], v[114:117]
    s_waitcnt lgkmcnt(8)
    v_mfma_f32_16x16x32_bf16 v[114:117], v[60:63], v[64:67], v[114:117]
    s_waitcnt lgkmcnt(6)
    v_mfma_f32_16x16x32_bf16 v[114:117], v[68:71], v[72:75], v[114:117]
    s_waitcnt lgkmcnt(4)
    v_mfma_f32_16x16x32_bf16 v[114:117], v[76:79], v[80:83], v[114:117]
    s_waitcnt lgkmcnt(2)
    v_mfma_f32_16x16x32_bf16 v[114:117], v[84:87], v[88:91], v[114:117]
    s_waitcnt lgkmcnt(0)
    v_mfma_f32_16x16x32_bf16 v[114:117], v[92:95], v[96:99], v[114:117]
    s_nop 7
    v_add_f32 v114, v114, v113
    ds_write_b64 v110, v[114:115] offset:50176
    ds_write_b64 v111, v[116:117] offset:50176
    s_branch K1_B2
K1_Q:
    v_lshlrev_b32 v165, 7, v4
    s_bitcmp0_b32 s2, 7
    s_cbranch_scc1 K1_NOPF2
    s_lshr_b32 s16, s2, 8
    s_lshl_b32 s16, s16, 4
    s_bfe_u32 s17, s2, 0x40003
    s_add_u32 s16, s16, s17
    s_and_b32 s18, s2, 7
    s_mov_b32 s14, 1966080
    s_mov_b32 s15, 0x20000
    s_cmp_ge_u32 s16, 30
    s_cbranch_scc1 K1_TW2
    s_cmp_ge_u32 s18, 4
    s_cselect_b32 s12, s6, s4
    s_cselect_b32 s13, s7, s5
    s_and_b32 s17, s18, 3
    s_mul_i32 s17, s17, 768
    s_lshl_b32 s16, s16, 7
    s_mov_b32 s19, 0xaaab
    v_add_u32 v20, s16, v4
    v_mul_u32_u24 v21, s19, v20
    v_lshrrev_b32 v21, 18, v21
    v_mul_u32_u24 v21, 2304, v21
    v_lshl_add_u32 v21, v20, 7, v21
    buffer_load_dword v164, v21, s[12:15], s17 offen
    v_add_u32 v20, s16, v4
    v_add_u32 v20, 64, v20
    v_mul_u32_u24 v21, s19, v20
    v_lshrrev_b32 v21, 18, v21
    v_mul_u32_u24 v21, 2304, v21
    v_lshl_add_u32 v21, v20, 7, v21
    buffer_load_dword v164, v21, s[12:15], s17 offen
    s_branch K1_TWD
K1_TW2:
    s_cmp_ge_u32 s16, 45
    s_cbranch_scc1 K1_TWD
    s_mov_b32 s12, s8
    s_mov_b32 s13, s9
    s_sub_u32 s16, s16, 30
    s_lshl_b32 s16, s16, 14
    s_mul_i32 s17, s18, 245760
    s_add_u32 s17, s17, s16
    buffer_load_dword v164, v165, s[12:15], s17 offen
    s_add_u32 s17, s17, 8192
    buffer_load_dword v164, v165, s[12:15], s17 offen
K1_TWD:
    s_cmp_ge_u32 s20, 32
    s_cbranch_scc1 K1_NOPF2
    s_lshr_b32 s16, s20, 3
    s_lshl_b32 s16, s16, 13
    v_add_u32 v165, s16, v165
    s_getpc_b64 s[12:13]
PFH4:
    s_add_u32 s12, s12, k3_kernel-PFH4
    s_addc_u32 s13, s13, 0
    s_mov_b32 s14, CODE_END-k3_kernel
    s_mov_b32 s15, 0x20000
    buffer_load_dword v164, v165, s[12:15], 0 offen
K1_NOPF2:
    s_mov_b32 m0, 0
    v_mul_f32 v20, v18, v8
    v_mul_f32 v21, v19, v9
    v_mul_f32 v23, v18, v10
    v_mul_f32 v24, v19, v11
    v_mul_f32 v26, v18, v12
    v_mul_f32 v27, v19, v13
    v_fract_f32 v21, v21
    v_fract_f32 v24, v24
    v_fract_f32 v27, v27
    v_exp_f32 v20, v20
    v_cos_f32 v22, v21
    v_sin_f32 v21, v21
    v_exp_f32 v23, v23
    v_cos_f32 v25, v24
    v_sin_f32 v24, v24
    v_exp_f32 v26, v26
    v_cos_f32 v28, v27
    v_sin_f32 v27, v27
    v_mul_f32 v32, v20, v22
    v_mul_f32 v33, v20, v21
    v_mul_f32 v40, v23, v25
    v_mul_f32 v41, v23, v24
    v_mul_f32 v48, v26, v28
    v_mul_f32 v49, v26, v27
    v_cvt_pk_bf16_f32 v96, 1.0, 0
    v_cvt_pk_bf16_f32 v97, 1.0, 0
    v_cvt_pk_bf16_f32 v98, 1.0, 0
    ds_write_addtid_b32 v96 offset:0
    ds_write_addtid_b32 v97 offset:256
    ds_write_addtid_b32 v98 offset:512
    v_cvt_pk_bf16_f32 v99, v32, v33
    v_cvt_pk_bf16_f32 v100, v40, v41
    v_cvt_pk_bf16_f32 v101, v48, v49
    ds_write_addtid_b32 v99 offset:800
    ds_write_addtid_b32 v100 offset:1056
    ds_write_addtid_b32 v101 offset:1312
    v_pk_mul_f32 v[38:39], v[32:33], v[32:33] op_sel:[0,0] op_sel_hi:[0,1]
    v_pk_mul_f32 v[46:47], v[40:41], v[40:41] op_sel:[0,0] op_sel_hi:[0,1]
    v_pk_mul_f32 v[54:55], v[48:49], v[48:49] op_sel:[0,0] op_sel_hi:[0,1]
    v_pk_fma_f32 v[38:39], v[32:33], v[32:33], v[38:39] op_sel:[1,1,0] op_sel_hi:[1,0,1] neg_lo:[0,1,0]
    v_pk_fma_f32 v[46:47], v[40:41], v[40:41], v[46:47] op_sel:[1,1,0] op_sel_hi:[1,0,1] neg_lo:[0,1,0]
    v_pk_fma_f32 v[54:55], v[48:49], v[48:49], v[54:55] op_sel:[1,1,0] op_sel_hi:[1,0,1] neg_lo:[0,1,0]
    v_cvt_pk_bf16_f32 v102, v38, v39
    v_cvt_pk_bf16_f32 v103, v46, v47
    v_cvt_pk_bf16_f32 v96, v54, v55
    ds_write_addtid_b32 v102 offset:1600
    ds_write_addtid_b32 v103 offset:1856
    ds_write_addtid_b32 v96 offset:2112
    v_pk_mul_f32 v[34:35], v[38:39], v[32:33] op_sel:[0,0] op_sel_hi:[0,1]
    v_pk_mul_f32 v[42:43], v[46:47], v[40:41] op_sel:[0,0] op_sel_hi:[0,1]
    v_pk_mul_f32 v[50:51], v[54:55], v[48:49] op_sel:[0,0] op_sel_hi:[0,1]
    v_pk_fma_f32 v[34:35], v[38:39], v[32:33], v[34:35] op_sel:[1,1,0] op_sel_hi:[1,0,1] neg_lo:[0,1,0]
    v_pk_fma_f32 v[42:43], v[46:47], v[40:41], v[42:43] op_sel:[1,1,0] op_sel_hi:[1,0,1] neg_lo:[0,1,0]
    v_pk_fma_f32 v[50:51], v[54:55], v[48:49], v[50:51] op_sel:[1,1,0] op_sel_hi:[1,0,1] neg_lo:[0,1,0]
    v_cvt_pk_bf16_f32 v97, v34, v35
    v_cvt_pk_bf16_f32 v98, v42, v43
    v_cvt_pk_bf16_f32 v99, v50, v51
    ds_write_addtid_b32 v97 offset:2400
    ds_write_addtid_b32 v98 offset:2656
    ds_write_addtid_b32 v99 offset:2912
    v_pk_mul_f32 v[36:37], v[34:35], v[32:33] op_sel:[0,0] op_sel_hi:[0,1]
    v_pk_mul_f32 v[44:45], v[42:43], v[40:41] op_sel:[0,0] op_sel_hi:[0,1]
    v_pk_mul_f32 v[52:53], v[50:51], v[48:49] op_sel:[0,0] op_sel_hi:[0,1]
    v_pk_fma_f32 v[36:37], v[34:35], v[32:33], v[36:37] op_sel:[1,1,0] op_sel_hi:[1,0,1] neg_lo:[0,1,0]
    v_pk_fma_f32 v[44:45], v[42:43], v[40:41], v[44:45] op_sel:[1,1,0] op_sel_hi:[1,0,1] neg_lo:[0,1,0]
    v_pk_fma_f32 v[52:53], v[50:51], v[48:49], v[52:53] op_sel:[1,1,0] op_sel_hi:[1,0,1] neg_lo:[0,1,0]
    v_cvt_pk_bf16_f32 v100, v36, v37
    v_cvt_pk_bf16_f32 v101, v44, v45
    v_cvt_pk_bf16_f32 v102, v52, v53
    ds_write_addtid_b32 v100 offset:3200
    ds_write_addtid_b32 v101 offset:3456
    ds_write_addtid_b32 v102 offset:3712
    v_pk_mul_f32 v[38:39], v[36:37], v[32:33] op_sel:[0,0] op_sel_hi:[0,1]
    v_pk_mul_f32 v[46:47], v[44:45], v[40:41] op_sel:[0,0] op_sel_hi:[0,1]
    v_pk_mul_f32 v[54:55], v[52:53], v[48:49] op_sel:[0,0] op_sel_hi:[0,1]
    v_pk_fma_f32 v[38:39], v[36:37], v[32:33], v[38:39] op_sel:[1,1,0] op_sel_hi:[1,0,1] neg_lo:[0,1,0]
    v_pk_fma_f32 v[46:47], v[44:45], v[40:41], v[46:47] op_sel:[1,1,0] op_sel_hi:[1,0,1] neg_lo:[0,1,0]
    v_pk_fma_f32 v[54:55], v[52:53], v[48:49], v[54:55] op_sel:[1,1,0] op_sel_hi:[1,0,1] neg_lo:[0,1,0]
    v_cvt_pk_bf16_f32 v103, v38, v39
    v_cvt_pk_bf16_f32 v96, v46, v47
    v_cvt_pk_bf16_f32 v97, v54, v55
    ds_write_addtid_b32 v103 offset:4000
    ds_write_addtid_b32 v96 offset:4256
    ds_write_addtid_b32 v97 offset:4512
    v_pk_mul_f32 v[34:35], v[38:39], v[32:33] op_sel:[0,0] op_sel_hi:[0,1]
    v_pk_mul_f32 v[42:43], v[46:47], v[40:41] op_sel:[0,0] op_sel_hi:[0,1]
    v_pk_mul_f32 v[50:51], v[54:55], v[48:49] op_sel:[0,0] op_sel_hi:[0,1]
    v_pk_fma_f32 v[34:35], v[38:39], v[32:33], v[34:35] op_sel:[1,1,0] op_sel_hi:[1,0,1] neg_lo:[0,1,0]
    v_pk_fma_f32 v[42:43], v[46:47], v[40:41], v[42:43] op_sel:[1,1,0] op_sel_hi:[1,0,1] neg_lo:[0,1,0]
    v_pk_fma_f32 v[50:51], v[54:55], v[48:49], v[50:51] op_sel:[1,1,0] op_sel_hi:[1,0,1] neg_lo:[0,1,0]
    v_cvt_pk_bf16_f32 v98, v34, v35
    v_cvt_pk_bf16_f32 v99, v42, v43
    v_cvt_pk_bf16_f32 v100, v50, v51
    ds_write_addtid_b32 v98 offset:4800
    ds_write_addtid_b32 v99 offset:5056
    ds_write_addtid_b32 v100 offset:5312
    v_pk_mul_f32 v[36:37], v[34:35], v[32:33] op_sel:[0,0] op_sel_hi:[0,1]
    v_pk_mul_f32 v[44:45], v[42:43], v[40:41] op_sel:[0,0] op_sel_hi:[0,1]
    v_pk_mul_f32 v[52:53], v[50:51], v[48:49] op_sel:[0,0] op_sel_hi:[0,1]
    v_pk_fma_f32 v[36:37], v[34:35], v[32:33], v[36:37] op_sel:[1,1,0] op_sel_hi:[1,0,1] neg_lo:[0,1,0]
    v_pk_fma_f32 v[44:45], v[42:43], v[40:41], v[44:45] op_sel:[1,1,0] op_sel_hi:[1,0,1] neg_lo:[0,1,0]
    v_pk_fma_f32 v[52:53], v[50:51], v[48:49], v[52:53] op_sel:[1,1,0] op_sel_hi:[1,0,1] neg_lo:[0,1,0]
    v_cvt_pk_bf16_f32 v101, v36, v37
    v_cvt_pk_bf16_f32 v102, v44, v45
    v_cvt_pk_bf16_f32 v103, v52, v53
    ds_write_addtid_b32 v101 offset:5600
    ds_write_addtid_b32 v102 offset:5856
    ds_write_addtid_b32 v103 offset:6112
    v_pk_mul_f32 v[38:39], v[36:37], v[32:33] op_sel:[0,0] op_sel_hi:[0,1]
    v_pk_mul_f32 v[46:47], v[44:45], v[40:41] op_sel:[0,0] op_sel_hi:[0,1]
    v_pk_mul_f32 v[54:55], v[52:53], v[48:49] op_sel:[0,0] op_sel_hi:[0,1]
    v_pk_fma_f32 v[38:39], v[36:37], v[32:33], v[38:39] op_sel:[1,1,0] op_sel_hi:[1,0,1] neg_lo:[0,1,0]
    v_pk_fma_f32 v[46:47], v[44:45], v[40:41], v[46:47] op_sel:[1,1,0] op_sel_hi:[1,0,1] neg_lo:[0,1,0]
    v_pk_fma_f32 v[54:55], v[52:53], v[48:49], v[54:55] op_sel:[1,1,0] op_sel_hi:[1,0,1] neg_lo:[0,1,0]
    v_cvt_pk_bf16_f32 v96, v38, v39
    v_cvt_pk_bf16_f32 v97, v46, v47
    v_cvt_pk_bf16_f32 v98, v54, v55
    ds_write_addtid_b32 v96 offset:6400
    ds_write_addtid_b32 v97 offset:6656
    ds_write_addtid_b32 v98 offset:6912
    v_pk_mul_f32 v[34:35], v[38:39], v[32:33] op_sel:[0,0] op_sel_hi:[0,1]
    v_pk_mul_f32 v[42:43], v[46:47], v[40:41] op_sel:[0,0] op_sel_hi:[0,1]
    v_pk_mul_f32 v[50:51], v[54:55], v[48:49] op_sel:[0,0] op_sel_hi:[0,1]
    v_pk_fma_f32 v[34:35], v[38:39], v[32:33], v[34:35] op_sel:[1,1,0] op_sel_hi:[1,0,1] neg_lo:[0,1,0]
    v_pk_fma_f32 v[42:43], v[46:47], v[40:41], v[42:43] op_sel:[1,1,0] op_sel_hi:[1,0,1] neg_lo:[0,1,0]
    v_pk_fma_f32 v[50:51], v[54:55], v[48:49], v[50:51] op_sel:[1,1,0] op_sel_hi:[1,0,1] neg_lo:[0,1,0]
    v_cvt_pk_bf16_f32 v99, v34, v35
    v_cvt_pk_bf16_f32 v100, v42, v43
    v_cvt_pk_bf16_f32 v101, v50, v51
    ds_write_addtid_b32 v99 offset:7200
    ds_write_addtid_b32 v100 offset:7456
    ds_write_addtid_b32 v101 offset:7712
    v_pk_mul_f32 v[36:37], v[34:35], v[32:33] op_sel:[0,0] op_sel_hi:[0,1]
    v_pk_mul_f32 v[44:45], v[42:43], v[40:41] op_sel:[0,0] op_sel_hi:[0,1]
    v_pk_mul_f32 v[52:53], v[50:51], v[48:49] op_sel:[0,0] op_sel_hi:[0,1]
    v_pk_fma_f32 v[36:37], v[34:35], v[32:33], v[36:37] op_sel:[1,1,0] op_sel_hi:[1,0,1] neg_lo:[0,1,0]
    v_pk_fma_f32 v[44:45], v[42:43], v[40:41], v[44:45] op_sel:[1,1,0] op_sel_hi:[1,0,1] neg_lo:[0,1,0]
    v_pk_fma_f32 v[52:53], v[50:51], v[48:49], v[52:53] op_sel:[1,1,0] op_sel_hi:[1,0,1] neg_lo:[0,1,0]
    v_cvt_pk_bf16_f32 v102, v36, v37
    v_cvt_pk_bf16_f32 v103, v44, v45
    v_cvt_pk_bf16_f32 v96, v52, v53
    ds_write_addtid_b32 v102 offset:8000
    ds_write_addtid_b32 v103 offset:8256
    ds_write_addtid_b32 v96 offset:8512
    v_pk_mul_f32 v[38:39], v[36:37], v[32:33] op_sel:[0,0] op_sel_hi:[0,1]
    v_pk_mul_f32 v[46:47], v[44:45], v[40:41] op_sel:[0,0] op_sel_hi:[0,1]
    v_pk_mul_f32 v[54:55], v[52:53], v[48:49] op_sel:[0,0] op_sel_hi:[0,1]
    v_pk_fma_f32 v[38:39], v[36:37], v[32:33], v[38:39] op_sel:[1,1,0] op_sel_hi:[1,0,1] neg_lo:[0,1,0]
    v_pk_fma_f32 v[46:47], v[44:45], v[40:41], v[46:47] op_sel:[1,1,0] op_sel_hi:[1,0,1] neg_lo:[0,1,0]
    v_pk_fma_f32 v[54:55], v[52:53], v[48:49], v[54:55] op_sel:[1,1,0] op_sel_hi:[1,0,1] neg_lo:[0,1,0]
    v_cvt_pk_bf16_f32 v97, v38, v39
    v_cvt_pk_bf16_f32 v98, v46, v47
    v_cvt_pk_bf16_f32 v99, v54, v55
    ds_write_addtid_b32 v97 offset:8800
    ds_write_addtid_b32 v98 offset:9056
    ds_write_addtid_b32 v99 offset:9312
    v_pk_mul_f32 v[34:35], v[38:39], v[32:33] op_sel:[0,0] op_sel_hi:[0,1]
    v_pk_mul_f32 v[42:43], v[46:47], v[40:41] op_sel:[0,0] op_sel_hi:[0,1]
    v_pk_mul_f32 v[50:51], v[54:55], v[48:49] op_sel:[0,0] op_sel_hi:[0,1]
    v_pk_fma_f32 v[34:35], v[38:39], v[32:33], v[34:35] op_sel:[1,1,0] op_sel_hi:[1,0,1] neg_lo:[0,1,0]
    v_pk_fma_f32 v[42:43], v[46:47], v[40:41], v[42:43] op_sel:[1,1,0] op_sel_hi:[1,0,1] neg_lo:[0,1,0]
    v_pk_fma_f32 v[50:51], v[54:55], v[48:49], v[50:51] op_sel:[1,1,0] op_sel_hi:[1,0,1] neg_lo:[0,1,0]
    v_cvt_pk_bf16_f32 v100, v34, v35
    v_cvt_pk_bf16_f32 v101, v42, v43
    v_cvt_pk_bf16_f32 v102, v50, v51
    ds_write_addtid_b32 v100 offset:9600
    ds_write_addtid_b32 v101 offset:9856
    ds_write_addtid_b32 v102 offset:10112
    v_pk_mul_f32 v[36:37], v[34:35], v[32:33] op_sel:[0,0] op_sel_hi:[0,1]
    v_pk_mul_f32 v[44:45], v[42:43], v[40:41] op_sel:[0,0] op_sel_hi:[0,1]
    v_pk_mul_f32 v[52:53], v[50:51], v[48:49] op_sel:[0,0] op_sel_hi:[0,1]
    v_pk_fma_f32 v[36:37], v[34:35], v[32:33], v[36:37] op_sel:[1,1,0] op_sel_hi:[1,0,1] neg_lo:[0,1,0]
    v_pk_fma_f32 v[44:45], v[42:43], v[40:41], v[44:45] op_sel:[1,1,0] op_sel_hi:[1,0,1] neg_lo:[0,1,0]
    v_pk_fma_f32 v[52:53], v[50:51], v[48:49], v[52:53] op_sel:[1,1,0] op_sel_hi:[1,0,1] neg_lo:[0,1,0]
    v_cvt_pk_bf16_f32 v103, v36, v37
    v_cvt_pk_bf16_f32 v96, v44, v45
    v_cvt_pk_bf16_f32 v97, v52, v53
    ds_write_addtid_b32 v103 offset:10400
    ds_write_addtid_b32 v96 offset:10656
    ds_write_addtid_b32 v97 offset:10912
    v_pk_mul_f32 v[38:39], v[36:37], v[32:33] op_sel:[0,0] op_sel_hi:[0,1]
    v_pk_mul_f32 v[46:47], v[44:45], v[40:41] op_sel:[0,0] op_sel_hi:[0,1]
    v_pk_mul_f32 v[54:55], v[52:53], v[48:49] op_sel:[0,0] op_sel_hi:[0,1]
    v_pk_fma_f32 v[38:39], v[36:37], v[32:33], v[38:39] op_sel:[1,1,0] op_sel_hi:[1,0,1] neg_lo:[0,1,0]
    v_pk_fma_f32 v[46:47], v[44:45], v[40:41], v[46:47] op_sel:[1,1,0] op_sel_hi:[1,0,1] neg_lo:[0,1,0]
    v_pk_fma_f32 v[54:55], v[52:53], v[48:49], v[54:55] op_sel:[1,1,0] op_sel_hi:[1,0,1] neg_lo:[0,1,0]
    v_cvt_pk_bf16_f32 v98, v38, v39
    v_cvt_pk_bf16_f32 v99, v46, v47
    v_cvt_pk_bf16_f32 v100, v54, v55
    ds_write_addtid_b32 v98 offset:11200
    ds_write_addtid_b32 v99 offset:11456
    ds_write_addtid_b32 v100 offset:11712
    v_pk_mul_f32 v[34:35], v[38:39], v[32:33] op_sel:[0,0] op_sel_hi:[0,1]
    v_pk_mul_f32 v[42:43], v[46:47], v[40:41] op_sel:[0,0] op_sel_hi:[0,1]
    v_pk_mul_f32 v[50:51], v[54:55], v[48:49] op_sel:[0,0] op_sel_hi:[0,1]
    v_pk_fma_f32 v[34:35], v[38:39], v[32:33], v[34:35] op_sel:[1,1,0] op_sel_hi:[1,0,1] neg_lo:[0,1,0]
    v_pk_fma_f32 v[42:43], v[46:47], v[40:41], v[42:43] op_sel:[1,1,0] op_sel_hi:[1,0,1] neg_lo:[0,1,0]
    v_pk_fma_f32 v[50:51], v[54:55], v[48:49], v[50:51] op_sel:[1,1,0] op_sel_hi:[1,0,1] neg_lo:[0,1,0]
    v_cvt_pk_bf16_f32 v101, v34, v35
    v_cvt_pk_bf16_f32 v102, v42, v43
    v_cvt_pk_bf16_f32 v103, v50, v51
    ds_write_addtid_b32 v101 offset:12000
    ds_write_addtid_b32 v102 offset:12256
    ds_write_addtid_b32 v103 offset:12512
    s_waitcnt lgkmcnt(0)
    s_barrier
    s_cmp_lt_u32 s2, 640
    s_cbranch_scc1 K1_NEQ
    buffer_load_dword v156, v152, s[68:71], 0 offen sc1
K1_NEQ:
K1_B2:
    s_waitcnt lgkmcnt(0)
    s_barrier
    ds_read_b32 v8, v136 offset:47615
    ds_read_b32 v9, v137 offset:47615
    ds_read_b32 v10, v138 offset:47615
    ds_read_b32 v11, v139 offset:47615
    ds_read_b32 v12, v140 offset:47615
    ds_read_b32 v13, v141 offset:47615
    ds_read_b32 v14, v142 offset:47615
    ds_read_b32 v15, v143 offset:47615
    ds_read_b32 v16, v144 offset:47615
    ds_read_b32 v17, v145 offset:47615
    ds_read_b32 v18, v146 offset:47615
    s_cmp_lt_u32 s2, 640
    s_cbranch_scc1 K1_NE2
    s_mov_b32 s27, 0
K1_R0_1:
    s_waitcnt vmcnt(0)
    v_cmp_ne_u32 vcc, 1, v156
    s_cbranch_vccz K1_R0_1D
    s_add_u32 s27, s27, 1
    s_cmp_ge_u32 s27, 200000
    s_cbranch_scc1 K1_R0_1D
    s_sleep 4
    buffer_load_dword v156, v152, s[68:71], 0 offen sc1
    s_branch K1_R0_1
K1_R0_1D:
    buffer_load_dword v156, v153, s[64:67], s33 offen sc1
    s_branch K1_NE3
K1_NE2:
    buffer_load_dword v156, v152, s[68:71], 0 offen sc1
K1_NE3:
    v_mov_b32 v6, 0
    v_mov_b32 v7, 0
    ds_write_b64 v166, v[6:7]
    ds_write_b64 v167, v[6:7] offset:16512
    s_waitcnt lgkmcnt(2)
    v_cvt_pk_bf16_f32 v20, v11, v12
    v_cvt_pk_bf16_f32 v21, v13, v14
    v_cvt_pk_bf16_f32 v22, v15, v16
    v_cvt_pk_bf16_f32 v23, v17, v18
    ds_write_b128 v112, v[20:23] offset:32
    v_cvt_pk_bf16_f32 v24, v10, v11
    v_cvt_pk_bf16_f32 v25, v12, v13
    v_cvt_pk_bf16_f32 v26, v14, v15
    v_cvt_pk_bf16_f32 v27, v16, v17
    ds_write_b128 v112, v[24:27] offset:4160
    v_cvt_pk_bf16_f32 v28, v9, v10
    v_cvt_pk_bf16_f32 v29, v11, v12
    v_cvt_pk_bf16_f32 v30, v13, v14
    v_cvt_pk_bf16_f32 v31, v15, v16
    ds_write_b128 v112, v[28:31] offset:8288
    v_cvt_pk_bf16_f32 v32, v8, v9
    v_cvt_pk_bf16_f32 v33, v10, v11
    v_cvt_pk_bf16_f32 v34, v12, v13
    v_cvt_pk_bf16_f32 v35, v14, v15
    ds_write_b128 v112, v[32:35] offset:12416
    s_waitcnt lgkmcnt(0)
    s_barrier
    ds_read_b64_tr_b16 v[8:9], v147 offset:288
    ds_read_b64_tr_b16 v[10:11], v147 offset:256
    ds_read_b64_tr_b16 v[16:17], v147 offset:800
    ds_read_b64_tr_b16 v[18:19], v147 offset:768
    ds_read_b64_tr_b16 v[24:25], v147 offset:1312
    ds_read_b64_tr_b16 v[26:27], v147 offset:1280
    ds_read_b64_tr_b16 v[32:33], v147 offset:1824
    ds_read_b64_tr_b16 v[34:35], v147 offset:1792
    ds_read_b64_tr_b16 v[40:41], v147 offset:2336
    ds_read_b64_tr_b16 v[42:43], v147 offset:2304
    ds_read_b64_tr_b16 v[48:49], v147 offset:2848
    ds_read_b64_tr_b16 v[50:51], v147 offset:2816
    ds_read_b64_tr_b16 v[56:57], v147 offset:3360
    ds_read_b64_tr_b16 v[58:59], v147 offset:3328
    ds_read_b64_tr_b16 v[64:65], v147 offset:3872
    ds_read_b64_tr_b16 v[66:67], v147 offset:3840
    ds_read_b64_tr_b16 v[4:5], v147 offset:32
    ds_read_b64_tr_b16 v[6:7], v147 offset:0
    ds_read_b64_tr_b16 v[12:13], v147 offset:544
    ds_read_b64_tr_b16 v[14:15], v147 offset:512
    ds_read_b64_tr_b16 v[20:21], v147 offset:1056
    ds_read_b64_tr_b16 v[22:23], v147 offset:1024
    ds_read_b64_tr_b16 v[28:29], v147 offset:1568
    ds_read_b64_tr_b16 v[30:31], v147 offset:1536
    ds_read_b64_tr_b16 v[36:37], v147 offset:2080
    ds_read_b64_tr_b16 v[38:39], v147 offset:2048
    ds_read_b64_tr_b16 v[44:45], v147 offset:2592
    ds_read_b64_tr_b16 v[46:47], v147 offset:2560
    ds_read_b64_tr_b16 v[52:53], v147 offset:3104
    ds_read_b64_tr_b16 v[54:55], v147 offset:3072
    ds_read_b64_tr_b16 v[60:61], v147 offset:3616
    ds_read_b64_tr_b16 v[62:63], v147 offset:3584
    s_cmp_ge_u32 s2, 640
    s_mov_b32 s27, 0
    s_cbranch_scc1 K1_POLL1C
    s_mov_b32 s27, 0
K1_R0_2:
    s_waitcnt vmcnt(0)
    v_cmp_ne_u32 vcc, 1, v156
    s_cbranch_vccz K1_R0_2D
    s_add_u32 s27, s27, 1
    s_cmp_ge_u32 s27, 200000
    s_cbranch_scc1 K1_R0_2D
    s_sleep 4
    buffer_load_dword v156, v152, s[68:71], 0 offen sc1
    s_branch K1_R0_2
K1_R0_2D:
    s_cmp_ge_u32 s2, 384
    s_cbranch_scc1 K1_HINTD
    s_lshr_b32 s31, s20, 3
    s_add_u32 s31, s31, s22
    s_and_b32 s31, s31, 7
    s_lshl_b32 s31, s31, 3
    s_and_b32 s32, s20, 7
    s_add_u32 s31, s31, s32
    s_lshl_b32 s31, s31, 7
    s_add_u32 s31, s31, 32768
    s_mov_b64 exec, 1
    s_mov_b32 s27, 0
K1_HINT:
    buffer_load_dword v156, v152, s[64:67], s31 offen sc1
    s_add_u32 s27, s27, 1
    s_cmp_ge_u32 s27, 200000
    s_cbranch_scc1 K1_HINTD
    s_waitcnt vmcnt(0)
    v_cmp_ne_u32 vcc, 1, v156
    s_cbranch_vccz K1_HINTD
    s_sleep 2
    s_branch K1_HINT
K1_HINTD:
    s_mov_b64 exec, -1
    s_mov_b32 s27, 0
K1_POLL1:
    buffer_load_dword v156, v153, s[64:67], s33 offen sc1
K1_POLL1C:
    s_waitcnt vmcnt(0)
    v_cmp_eq_u32 vcc, 1, v156
    s_and_saveexec_b64 s[34:35], vcc
    s_cbranch_execz K1_PC_3
    buffer_load_dwordx4 v[158:161], v155, s[56:59], s30 offen sc1
K1_PC_3:
    s_andn2_b64 exec, s[34:35], exec
    s_cbranch_execz K1_POLL1D
    s_add_u32 s27, s27, 1
    s_cmp_ge_u32 s27, 200000
    s_cbranch_scc1 K1_POLL1D
    s_sleep 4
    s_branch K1_POLL1
K1_POLL1D:
    s_mov_b64 exec, -1
    s_waitcnt vmcnt(0)
    buffer_load_dwordx4 v[136:139], v149, s[64:67], 0 offen sc1
    buffer_load_dwordx4 v[140:143], v149, s[64:67], 0 offen offset:16 sc1
    ds_write_b64 v154, v[158:159] offset:16640
    ds_write_b64 v154, v[160:161] offset:17792
    ds_write_b64 v154, v[158:159] offset:21384
    ds_write_b64 v154, v[160:161] offset:22536
    s_waitcnt lgkmcnt(0)
    s_barrier
    s_setprio 0
    ds_read_b128 v[68:71], v148 offset:0
    ds_read_b128 v[72:75], v148 offset:64
    ds_read_b128 v[76:79], v148 offset:128
    ds_read_b128 v[80:83], v148 offset:192
    ds_read_b128 v[84:87], v148 offset:256
    s_waitcnt lgkmcnt(4)
    v_mfma_f32_16x16x32_bf16 v[104:107], v[8:11], v[68:71], 0
    ds_read_b32 v100, v157 offset:16640
    ds_read_b32 v101, v157 offset:17792
    v_mfma_f32_16x16x32_bf16 v[108:111], v[16:19], v[68:71], 0
    ds_read_b32 v102, v157 offset:18944
    ds_read_b32 v103, v157 offset:20096
    v_mfma_f32_16x16x32_bf16 v[112:115], v[24:27], v[68:71], 0
    ds_read_b128 v[88:91], v148 offset:320
    v_mfma_f32_16x16x32_bf16 v[116:119], v[32:35], v[68:71], 0
    v_mfma_f32_16x16x32_bf16 v[120:123], v[40:43], v[68:71], 0
    v_mfma_f32_16x16x32_bf16 v[124:127], v[48:51], v[68:71], 0
    v_mfma_f32_16x16x32_bf16 v[128:131], v[56:59], v[68:71], 0
    v_mfma_f32_16x16x32_bf16 v[132:135], v[64:67], v[68:71], 0
    s_waitcnt lgkmcnt(8)
    v_mfma_f32_16x16x32_bf16 v[104:107], v[4:7], v[72:75], v[104:107]
    ds_read_b128 v[68:71], v148 offset:384
    v_mfma_f32_16x16x32_bf16 v[108:111], v[12:15], v[72:75], v[108:111]
    v_mfma_f32_16x16x32_bf16 v[112:115], v[20:23], v[72:75], v[112:115]
    v_mfma_f32_16x16x32_bf16 v[116:119], v[28:31], v[72:75], v[116:119]
    v_mfma_f32_16x16x32_bf16 v[120:123], v[36:39], v[72:75], v[120:123]
    s_nop 2
    ds_write_b128 v162, v[104:107] offset:25872
    v_mfma_f32_16x16x32_bf16 v[124:127], v[44:47], v[72:75], v[124:127]
    v_mfma_f32_16x16x32_bf16 v[128:131], v[52:55], v[72:75], v[128:131]
    v_mfma_f32_16x16x32_bf16 v[132:135], v[60:63], v[72:75], v[132:135]
    s_waitcnt lgkmcnt(9)
    v_mfma_f32_16x16x32_bf16 v[108:111], v[8:11], v[76:79], v[108:111]
    ds_read_b128 v[72:75], v148 offset:448
    v_mfma_f32_16x16x32_bf16 v[112:115], v[16:19], v[76:79], v[112:115]
    v_mfma_f32_16x16x32_bf16 v[116:119], v[24:27], v[76:79], v[116:119]
    v_mfma_f32_16x16x32_bf16 v[120:123], v[32:35], v[76:79], v[120:123]
    v_mfma_f32_16x16x32_bf16 v[124:127], v[40:43], v[76:79], v[124:127]
    v_mfma_f32_16x16x32_bf16 v[128:131], v[48:51], v[76:79], v[128:131]
    v_mfma_f32_16x16x32_bf16 v[132:135], v[56:59], v[76:79], v[132:135]
    s_waitcnt lgkmcnt(9)
    v_mfma_f32_16x16x32_bf16 v[108:111], v[4:7], v[80:83], v[108:111]
    ds_read_b128 v[76:79], v148 offset:512
    v_mfma_f32_16x16x32_bf16 v[112:115], v[12:15], v[80:83], v[112:115]
    v_mfma_f32_16x16x32_bf16 v[116:119], v[20:23], v[80:83], v[116:119]
    v_mfma_f32_16x16x32_bf16 v[120:123], v[28:31], v[80:83], v[120:123]
    v_mfma_f32_16x16x32_bf16 v[124:127], v[36:39], v[80:83], v[124:127]
    s_nop 2
    ds_write_b128 v162, v[108:111] offset:26896
    v_mfma_f32_16x16x32_bf16 v[128:131], v[44:47], v[80:83], v[128:131]
    v_mfma_f32_16x16x32_bf16 v[132:135], v[52:55], v[80:83], v[132:135]
    s_waitcnt lgkmcnt(10)
    v_mfma_f32_16x16x32_bf16 v[112:115], v[8:11], v[84:87], v[112:115]
    ds_read_b128 v[80:83], v148 offset:576
    v_mfma_f32_16x16x32_bf16 v[116:119], v[16:19], v[84:87], v[116:119]
    v_mfma_f32_16x16x32_bf16 v[120:123], v[24:27], v[84:87], v[120:123]
    v_mfma_f32_16x16x32_bf16 v[124:127], v[32:35], v[84:87], v[124:127]
    v_mfma_f32_16x16x32_bf16 v[128:131], v[40:43], v[84:87], v[128:131]
    v_mfma_f32_16x16x32_bf16 v[132:135], v[48:51], v[84:87], v[132:135]
    s_waitcnt lgkmcnt(6)
    v_mfma_f32_16x16x32_bf16 v[112:115], v[4:7], v[88:91], v[112:115]
    ds_read_b128 v[84:87], v148 offset:640
    v_mfma_f32_16x16x32_bf16 v[116:119], v[12:15], v[88:91], v[116:119]
    v_mfma_f32_16x16x32_bf16 v[120:123], v[20:23], v[88:91], v[120:123]
    v_mfma_f32_16x16x32_bf16 v[124:127], v[28:31], v[88:91], v[124:127]
    v_mfma_f32_16x16x32_bf16 v[128:131], v[36:39], v[88:91], v[128:131]
    s_nop 2
    ds_write_b128 v162, v[112:115] offset:27920
    v_mfma_f32_16x16x32_bf16 v[132:135], v[44:47], v[88:91], v[132:135]
    s_waitcnt lgkmcnt(7)
    v_mfma_f32_16x16x32_bf16 v[116:119], v[8:11], v[68:71], v[116:119]
    ds_read_b128 v[88:91], v148 offset:704
    v_mfma_f32_16x16x32_bf16 v[120:123], v[16:19], v[68:71], v[120:123]
    v_mfma_f32_16x16x32_bf16 v[124:127], v[24:27], v[68:71], v[124:127]
    v_mfma_f32_16x16x32_bf16 v[128:131], v[32:35], v[68:71], v[128:131]
    v_mfma_f32_16x16x32_bf16 v[132:135], v[40:43], v[68:71], v[132:135]
    s_waitcnt lgkmcnt(6)
    v_mfma_f32_16x16x32_bf16 v[116:119], v[4:7], v[72:75], v[116:119]
    ds_read_b128 v[68:71], v148 offset:768
    v_mfma_f32_16x16x32_bf16 v[120:123], v[12:15], v[72:75], v[120:123]
    s_waitcnt vmcnt(0)
    v_lshlrev_b32 v92, 16, v136
    v_mfma_f32_16x16x32_bf16 v[124:127], v[20:23], v[72:75], v[124:127]
    v_and_b32 v136, 0xffff0000, v136
    v_lshlrev_b32 v93, 16, v137
    v_mfma_f32_16x16x32_bf16 v[128:131], v[28:31], v[72:75], v[128:131]
    v_and_b32 v137, 0xffff0000, v137
    v_lshlrev_b32 v94, 16, v138
    v_mfma_f32_16x16x32_bf16 v[132:135], v[36:39], v[72:75], v[132:135]
    ds_write_b128 v162, v[116:119] offset:28944
    s_waitcnt lgkmcnt(7)
    v_mfma_f32_16x16x32_bf16 v[120:123], v[8:11], v[76:79], v[120:123]
    ds_read_b128 v[72:75], v148 offset:832
    v_mfma_f32_16x16x32_bf16 v[124:127], v[16:19], v[76:79], v[124:127]
    v_and_b32 v138, 0xffff0000, v138
    v_lshlrev_b32 v95, 16, v139
    v_mfma_f32_16x16x32_bf16 v[128:131], v[24:27], v[76:79], v[128:131]
    v_and_b32 v139, 0xffff0000, v139
    v_lshlrev_b32 v96, 16, v140
    v_mfma_f32_16x16x32_bf16 v[132:135], v[32:35], v[76:79], v[132:135]
    v_and_b32 v140, 0xffff0000, v140
    v_lshlrev_b32 v97, 16, v141
    s_waitcnt lgkmcnt(6)
    v_mfma_f32_16x16x32_bf16 v[120:123], v[4:7], v[80:83], v[120:123]
    ds_read_b128 v[76:79], v148 offset:896
    v_mfma_f32_16x16x32_bf16 v[124:127], v[12:15], v[80:83], v[124:127]
    v_and_b32 v141, 0xffff0000, v141
    v_lshlrev_b32 v98, 16, v142
    v_mfma_f32_16x16x32_bf16 v[128:131], v[20:23], v[80:83], v[128:131]
    v_and_b32 v142, 0xffff0000, v142
    v_lshlrev_b32 v99, 16, v143
    v_mfma_f32_16x16x32_bf16 v[132:135], v[28:31], v[80:83], v[132:135]
    v_and_b32 v143, 0xffff0000, v143
    v_lshlrev_b32 v144, 16, v100
    s_waitcnt lgkmcnt(6)
    v_mfma_f32_16x16x32_bf16 v[124:127], v[8:11], v[84:87], v[124:127]
    ds_write_b128 v162, v[120:123] offset:32
    v_mfma_f32_16x16x32_bf16 v[128:131], v[16:19], v[84:87], v[128:131]
    ds_read_b128 v[80:83], v148 offset:960
    v_mfma_f32_16x16x32_bf16 v[132:135], v[24:27], v[84:87], v[132:135]
    v_lshlrev_b32 v145, 16, v101
    v_lshlrev_b32 v146, 16, v102
    s_waitcnt lgkmcnt(6)
    v_mfma_f32_16x16x32_bf16 v[124:127], v[4:7], v[88:91], v[124:127]
    v_lshlrev_b32 v147, 16, v103
    v_fmac_f32 v92, v136, v144
    v_mfma_f32_16x16x32_bf16 v[128:131], v[12:15], v[88:91], v[128:131]
    v_fmac_f32 v93, v137, v145
    v_fmac_f32 v94, v138, v146
    v_mfma_f32_16x16x32_bf16 v[132:135], v[20:23], v[88:91], v[132:135]
    v_fmac_f32 v95, v139, v147
    v_and_b32 v144, 0xffff0000, v100
    s_waitcnt lgkmcnt(5)
    v_mfma_f32_16x16x32_bf16 v[128:131], v[8:11], v[68:71], v[128:131]
    v_and_b32 v145, 0xffff0000, v101
    v_and_b32 v146, 0xffff0000, v102
    v_mfma_f32_16x16x32_bf16 v[132:135], v[16:19], v[68:71], v[132:135]
    ds_write_b128 v162, v[124:127] offset:1056
    s_waitcnt lgkmcnt(4)
    v_mfma_f32_16x16x32_bf16 v[128:131], v[4:7], v[72:75], v[128:131]
    v_and_b32 v147, 0xffff0000, v103
    v_fmac_f32 v96, v140, v144
    v_mfma_f32_16x16x32_bf16 v[132:135], v[12:15], v[72:75], v[132:135]
    v_fmac_f32 v97, v141, v145
    v_fmac_f32 v98, v142, v146
    s_waitcnt lgkmcnt(3)
    v_mfma_f32_16x16x32_bf16 v[132:135], v[8:11], v[76:79], v[132:135]
    v_fmac_f32 v99, v143, v147
    s_waitcnt lgkmcnt(1)
    v_mfma_f32_16x16x32_bf16 v[132:135], v[4:7], v[80:83], v[132:135]
    s_setprio 1
    ds_write_b128 v162, v[128:131] offset:2080
    s_nop 5
    ds_write_b128 v162, v[132:135] offset:3104
    s_waitcnt lgkmcnt(0)
    s_barrier
    ds_read_b128 v[4:7], v163 offset:32
    ds_read_b128 v[8:11], v163 offset:288
    ds_read_b128 v[12:15], v163 offset:4160
    ds_read_b128 v[16:19], v163 offset:4416
    ds_read_b128 v[20:23], v163 offset:8288
    ds_read_b128 v[24:27], v163 offset:8544
    ds_read_b128 v[28:31], v163 offset:12416
    ds_read_b128 v[32:35], v163 offset:12672
    s_waitcnt lgkmcnt(6)
    v_add_f32 v92, v92, v4
    v_add_f32 v93, v93, v5
    v_add_f32 v94, v94, v6
    v_add_f32 v95, v95, v7
    v_add_f32 v96, v96, v8
    v_add_f32 v97, v97, v9
    v_add_f32 v98, v98, v10
    v_add_f32 v99, v99, v11
    s_waitcnt lgkmcnt(4)
    v_add_f32 v92, v92, v12
    v_add_f32 v93, v93, v13
    v_add_f32 v94, v94, v14
    v_add_f32 v95, v95, v15
    v_add_f32 v96, v96, v16
    v_add_f32 v97, v97, v17
    v_add_f32 v98, v98, v18
    v_add_f32 v99, v99, v19
    s_waitcnt lgkmcnt(2)
    v_add_f32 v92, v92, v20
    v_add_f32 v93, v93, v21
    v_add_f32 v94, v94, v22
    v_add_f32 v95, v95, v23
    v_add_f32 v96, v96, v24
    v_add_f32 v97, v97, v25
    v_add_f32 v98, v98, v26
    v_add_f32 v99, v99, v27
    s_waitcnt lgkmcnt(0)
    v_add_f32 v92, v92, v28
    v_add_f32 v93, v93, v29
    v_add_f32 v94, v94, v30
    v_add_f32 v95, v95, v31
    v_add_f32 v96, v96, v32
    v_add_f32 v97, v97, v33
    v_add_f32 v98, v98, v34
    v_add_f32 v99, v99, v35
    v_cvt_pk_bf16_f32 v40, v92, v93
    v_cvt_pk_bf16_f32 v41, v94, v95
    v_cvt_pk_bf16_f32 v42, v96, v97
    v_cvt_pk_bf16_f32 v43, v98, v99
    buffer_store_dwordx4 v[40:43], v150, s[60:63], s29 offen sc1
K1_END:
    s_endpgm
.globl k3_kernel
.p2align 8
.type k3_kernel,@function
k3_kernel:
    s_cmp_ge_u32 s2, 256
    s_cbranch_scc1 K3_END
    s_load_dwordx2 s[16:17], s[0:1], 120
    s_load_dwordx2 s[6:7], s[0:1], 104
    v_lshrrev_b32 v1, 6, v0
    v_and_b32 v2, 63, v0
    v_readfirstlane_b32 s22, v1
    s_and_b32 s3, s2, 7
    s_lshr_b32 s18, s2, 3
    s_lshr_b32 s19, s18, 2
    s_and_b32 s21, s18, 3
    s_lshr_b32 s23, s3, 2
    s_lshl_b32 s23, s23, 3
    s_add_u32 s23, s23, s19
    s_and_b32 s24, s3, 3
    s_lshl_b32 s24, s24, 2
    s_add_u32 s24, s24, s21
    s_and_b32 s20, s3, 1
    s_lshl_b32 s20, s20, 2
    s_add_u32 s20, s20, s21
    s_lshr_b32 s5, s3, 1
    s_lshl_b32 s5, s5, 3
    s_add_u32 s5, s5, s19
    s_mov_b32 s4, s19
    s_mov_b32 s63, s21
    s_cmp_lt_u32 s22, 4
    s_cbranch_scc1 K3_COMP
    s_sub_u32 s22, s22, 4
    v_lshrrev_b32 v7, 4, v2
    v_and_b32 v9, 15, v2
    v_lshlrev_b32 v8, 11, v7
    v_lshl_add_u32 v8, v9, 4, v8
    v_lshlrev_b32 v10, 4, v2
    s_mul_i32 s27, s23, 163840
    s_lshl_b32 s26, s22, 9
    s_add_u32 s27, s27, s26
    s_mul_i32 s28, s24, 245760
    s_mul_i32 s26, s22, 3072
    s_add_u32 s28, s28, s26
    s_mul_i32 s29, s22, 2112
    s_add_u32 s29, s29, 76800
    s_add_u32 s30, s26, 85248
    s_waitcnt lgkmcnt(0)
    s_add_u32 s12, s16, 0x780000
    s_addc_u32 s13, s17, 0
    s_mov_b32 s14, 0x280000
    s_mov_b32 s15, 0x20000
    s_add_u32 s8, s16, 0x1200000
    s_addc_u32 s9, s17, 0
    s_mov_b32 s10, 0x3c0000
    s_mov_b32 s11, 0x20000
    s_add_u32 m0, s30, 0
    s_add_u32 s31, s28, 0
    s_add_u32 s32, s27, 0
    s_add_u32 s34, s27, 256
    buffer_load_dwordx4 v10, s[8:11], s31 offen offset:0 lds
    buffer_load_dwordx4 v10, s[8:11], s31 offen offset:1024 lds
    buffer_load_dwordx4 v10, s[8:11], s31 offen offset:2048 lds
    s_add_u32 m0, s29, 0
    s_nop 0
    buffer_load_dwordx4 v8, s[12:15], s32 offen lds
    s_add_u32 m0, s29, 1056
    s_nop 0
    buffer_load_dwordx4 v8, s[12:15], s34 offen lds
    s_add_u32 m0, s30, 20736
    s_add_u32 s31, s28, 12288
    s_add_u32 s32, s27, 8192
    s_add_u32 s34, s27, 8448
    buffer_load_dwordx4 v10, s[8:11], s31 offen offset:0 lds
    buffer_load_dwordx4 v10, s[8:11], s31 offen offset:1024 lds
    buffer_load_dwordx4 v10, s[8:11], s31 offen offset:2048 lds
    s_add_u32 m0, s29, 20736
    s_nop 0
    buffer_load_dwordx4 v8, s[12:15], s32 offen lds
    s_add_u32 m0, s29, 21792
    s_nop 0
    buffer_load_dwordx4 v8, s[12:15], s34 offen lds
    s_add_u32 m0, s30, 41472
    s_add_u32 s31, s28, 24576
    s_add_u32 s32, s27, 16384
    s_add_u32 s34, s27, 16640
    buffer_load_dwordx4 v10, s[8:11], s31 offen offset:0 lds
    buffer_load_dwordx4 v10, s[8:11], s31 offen offset:1024 lds
    buffer_load_dwordx4 v10, s[8:11], s31 offen offset:2048 lds
    s_add_u32 m0, s29, 41472
    s_nop 0
    buffer_load_dwordx4 v8, s[12:15], s32 offen lds
    s_add_u32 m0, s29, 42528
    s_nop 0
    buffer_load_dwordx4 v8, s[12:15], s34 offen lds
    s_add_u32 s44, s16, 0x1600000
    s_addc_u32 s45, s17, 0
    s_mov_b32 s46, 0x1e0000
    s_mov_b32 s47, 0x20000
    s_mul_i32 s48, s20, 245760
    s_lshl_b32 s49, s22, 10
    s_add_u32 s48, s48, s49
    v_bfe_u32 v3, v2, 2, 3
    v_mul_u32_u24 v12, 1056, v3
    v_lshrrev_b32 v3, 5, v2
    v_lshl_add_u32 v12, v3, 8, v12
    v_and_b32 v3, 3, v2
    v_lshl_add_u32 v12, v3, 3, v12
    s_lshl_b32 s26, s22, 6
    v_add_u32 v12, s26, v12
    s_mov_b32 s33, 0x3f803f80
    s_add_u32 s36, s16, 0x1020000
    s_addc_u32 s37, s17, 0
    s_mov_b32 s38, 0x50000
    s_mov_b32 s39, 0x20000
    s_add_u32 s52, s16, 0x1100000
    s_addc_u32 s53, s17, 0
    s_mov_b32 s54, 0x28000
    s_mov_b32 s55, 0x20000
    v_and_b32 v13, 31, v2
    s_lshl_b32 s26, s22, 8
    v_lshl_add_u32 v13, v13, 3, s26
    s_add_u32 m0, s30, 62208
    s_add_u32 s31, s28, 36864
    s_add_u32 s32, s27, 24576
    s_add_u32 s34, s27, 24832
    s_waitcnt vmcnt(10)
    s_waitcnt lgkmcnt(0)
    s_barrier
    buffer_load_dwordx4 v10, s[8:11], s31 offen offset:0 lds
    buffer_load_dwordx4 v10, s[8:11], s31 offen offset:1024 lds
    buffer_load_dwordx4 v10, s[8:11], s31 offen offset:2048 lds
    s_add_u32 m0, s29, 62208
    s_nop 0
    buffer_load_dwordx4 v8, s[12:15], s32 offen lds
    s_add_u32 m0, s29, 63264
    s_nop 0
    buffer_load_dwordx4 v8, s[12:15], s34 offen lds
    s_cmp_eq_u32 s24, 0
    s_cbranch_scc1 K3_ST0
K3_STR0:
    s_add_u32 m0, s30, 0
    s_add_u32 s31, s28, 49152
    s_add_u32 s32, s27, 32768
    s_add_u32 s34, s27, 33024
    s_waitcnt vmcnt(10)
    s_waitcnt lgkmcnt(0)
    s_barrier
    buffer_load_dwordx4 v10, s[8:11], s31 offen offset:0 lds
    buffer_load_dwordx4 v10, s[8:11], s31 offen offset:1024 lds
    buffer_load_dwordx4 v10, s[8:11], s31 offen offset:2048 lds
    s_add_u32 m0, s29, 0
    s_nop 0
    buffer_load_dwordx4 v8, s[12:15], s32 offen lds
    s_add_u32 m0, s29, 1056
    s_nop 0
    buffer_load_dwordx4 v8, s[12:15], s34 offen lds
    s_cmp_eq_u32 s24, 1
    s_cbranch_scc1 K3_ST1
K3_STR1:
    s_add_u32 s31, s48, 0
    s_add_u32 m0, s49, 0
    s_nop 0
    buffer_load_dwordx4 v10, s[44:47], s31 offen lds
    s_add_u32 m0, s30, 20736
    s_add_u32 s31, s28, 61440
    s_add_u32 s32, s27, 40960
    s_add_u32 s34, s27, 41216
    s_waitcnt vmcnt(11)
    s_waitcnt lgkmcnt(0)
    s_barrier
    buffer_load_dwordx4 v10, s[8:11], s31 offen offset:0 lds
    buffer_load_dwordx4 v10, s[8:11], s31 offen offset:1024 lds
    buffer_load_dwordx4 v10, s[8:11], s31 offen offset:2048 lds
    s_add_u32 m0, s29, 20736
    s_nop 0
    buffer_load_dwordx4 v8, s[12:15], s32 offen lds
    s_add_u32 m0, s29, 21792
    s_nop 0
    buffer_load_dwordx4 v8, s[12:15], s34 offen lds
    s_cmp_eq_u32 s24, 2
    s_cbranch_scc1 K3_ST2
K3_STR2:
    s_add_u32 s31, s48, 4096
    s_add_u32 m0, s49, 4096
    s_nop 0
    buffer_load_dwordx4 v10, s[44:47], s31 offen lds
    s_add_u32 m0, s30, 41472
    s_add_u32 s31, s28, 73728
    s_add_u32 s32, s27, 49152
    s_add_u32 s34, s27, 49408
    s_waitcnt vmcnt(12)
    s_waitcnt lgkmcnt(0)
    s_barrier
    buffer_load_dwordx4 v10, s[8:11], s31 offen offset:0 lds
    buffer_load_dwordx4 v10, s[8:11], s31 offen offset:1024 lds
    buffer_load_dwordx4 v10, s[8:11], s31 offen offset:2048 lds
    s_add_u32 m0, s29, 41472
    s_nop 0
    buffer_load_dwordx4 v8, s[12:15], s32 offen lds
    s_add_u32 m0, s29, 42528
    s_nop 0
    buffer_load_dwordx4 v8, s[12:15], s34 offen lds
    s_cmp_eq_u32 s24, 3
    s_cbranch_scc1 K3_ST3
K3_STR3:
    s_add_u32 s31, s48, 8192
    s_add_u32 m0, s49, 8192
    s_nop 0
    buffer_load_dwordx4 v10, s[44:47], s31 offen lds
    s_add_u32 m0, s30, 62208
    s_add_u32 s31, s28, 86016
    s_add_u32 s32, s27, 57344
    s_add_u32 s34, s27, 57600
    s_waitcnt vmcnt(13)
    s_waitcnt lgkmcnt(0)
    s_barrier
    buffer_load_dwordx4 v10, s[8:11], s31 offen offset:0 lds
    buffer_load_dwordx4 v10, s[8:11], s31 offen offset:1024 lds
    buffer_load_dwordx4 v10, s[8:11], s31 offen offset:2048 lds
    s_add_u32 m0, s29, 62208
    s_nop 0
    buffer_load_dwordx4 v8, s[12:15], s32 offen lds
    s_add_u32 m0, s29, 63264
    s_nop 0
    buffer_load_dwordx4 v8, s[12:15], s34 offen lds
    s_cmp_eq_u32 s24, 4
    s_cbranch_scc1 K3_ST4
K3_STR4:
    s_add_u32 s31, s48, 12288
    s_add_u32 m0, s49, 12288
    s_nop 0
    buffer_load_dwordx4 v10, s[44:47], s31 offen lds
    s_add_u32 m0, s30, 0
    s_add_u32 s31, s28, 98304
    s_add_u32 s32, s27, 65536
    s_add_u32 s34, s27, 65792
    s_waitcnt vmcnt(13)
    s_waitcnt lgkmcnt(0)
    s_barrier
    buffer_load_dwordx4 v10, s[8:11], s31 offen offset:0 lds
    buffer_load_dwordx4 v10, s[8:11], s31 offen offset:1024 lds
    buffer_load_dwordx4 v10, s[8:11], s31 offen offset:2048 lds
    s_add_u32 m0, s29, 0
    s_nop 0
    buffer_load_dwordx4 v8, s[12:15], s32 offen lds
    s_add_u32 m0, s29, 1056
    s_nop 0
    buffer_load_dwordx4 v8, s[12:15], s34 offen lds
    s_cmp_eq_u32 s24, 5
    s_cbranch_scc1 K3_ST5
K3_STR5:
    s_add_u32 s31, s48, 16384
    s_add_u32 m0, s49, 16384
    s_nop 0
    buffer_load_dwordx4 v10, s[44:47], s31 offen lds
    s_add_u32 m0, s30, 20736
    s_add_u32 s31, s28, 110592
    s_add_u32 s32, s27, 73728
    s_add_u32 s34, s27, 73984
    s_waitcnt vmcnt(13)
    s_waitcnt lgkmcnt(0)
    s_barrier
    buffer_load_dwordx4 v10, s[8:11], s31 offen offset:0 lds
    buffer_load_dwordx4 v10, s[8:11], s31 offen offset:1024 lds
    buffer_load_dwordx4 v10, s[8:11], s31 offen offset:2048 lds
    s_add_u32 m0, s29, 20736
    s_nop 0
    buffer_load_dwordx4 v8, s[12:15], s32 offen lds
    s_add_u32 m0, s29, 21792
    s_nop 0
    buffer_load_dwordx4 v8, s[12:15], s34 offen lds
    s_cmp_eq_u32 s24, 6
    s_cbranch_scc1 K3_ST6
K3_STR6:
    s_add_u32 s31, s48, 20480
    s_add_u32 m0, s49, 20480
    s_nop 0
    buffer_load_dwordx4 v10, s[44:47], s31 offen lds
    s_add_u32 m0, s30, 41472
    s_add_u32 s31, s28, 122880
    s_add_u32 s32, s27, 81920
    s_add_u32 s34, s27, 82176
    s_waitcnt vmcnt(13)
    s_waitcnt lgkmcnt(0)
    s_barrier
    buffer_load_dwordx4 v10, s[8:11], s31 offen offset:0 lds
    buffer_load_dwordx4 v10, s[8:11], s31 offen offset:1024 lds
    buffer_load_dwordx4 v10, s[8:11], s31 offen offset:2048 lds
    s_add_u32 m0, s29, 41472
    s_nop 0
    buffer_load_dwordx4 v8, s[12:15], s32 offen lds
    s_add_u32 m0, s29, 42528
    s_nop 0
    buffer_load_dwordx4 v8, s[12:15], s34 offen lds
    s_cmp_eq_u32 s24, 7
    s_cbranch_scc1 K3_ST7
K3_STR7:
    s_add_u32 s31, s48, 24576
    s_add_u32 m0, s49, 24576
    s_nop 0
    buffer_load_dwordx4 v10, s[44:47], s31 offen lds
    s_add_u32 m0, s30, 62208
    s_add_u32 s31, s28, 135168
    s_add_u32 s32, s27, 90112
    s_add_u32 s34, s27, 90368
    s_waitcnt vmcnt(13)
    s_waitcnt lgkmcnt(0)
    s_barrier
    buffer_load_dwordx4 v10, s[8:11], s31 offen offset:0 lds
    buffer_load_dwordx4 v10, s[8:11], s31 offen offset:1024 lds
    buffer_load_dwordx4 v10, s[8:11], s31 offen offset:2048 lds
    s_add_u32 m0, s29, 62208
    s_nop 0
    buffer_load_dwordx4 v8, s[12:15], s32 offen lds
    s_add_u32 m0, s29, 63264
    s_nop 0
    buffer_load_dwordx4 v8, s[12:15], s34 offen lds
    s_cmp_eq_u32 s24, 8
    s_cbranch_scc1 K3_ST8
K3_STR8:
    s_add_u32 s31, s48, 28672
    s_add_u32 m0, s49, 28672
    s_nop 0
    buffer_load_dwordx4 v10, s[44:47], s31 offen lds
    s_add_u32 m0, s30, 0
    s_add_u32 s31, s28, 147456
    s_add_u32 s32, s27, 98304
    s_add_u32 s34, s27, 98560
    s_waitcnt vmcnt(13)
    s_waitcnt lgkmcnt(0)
    s_barrier
    buffer_load_dwordx4 v10, s[8:11], s31 offen offset:0 lds
    buffer_load_dwordx4 v10, s[8:11], s31 offen offset:1024 lds
    buffer_load_dwordx4 v10, s[8:11], s31 offen offset:2048 lds
    s_add_u32 m0, s29, 0
    s_nop 0
    buffer_load_dwordx4 v8, s[12:15], s32 offen lds
    s_add_u32 m0, s29, 1056
    s_nop 0
    buffer_load_dwordx4 v8, s[12:15], s34 offen lds
    s_cmp_eq_u32 s24, 9
    s_cbranch_scc1 K3_ST9
K3_STR9:
    s_add_u32 s31, s48, 32768
    s_add_u32 m0, s49, 32768
    s_nop 0
    buffer_load_dwordx4 v10, s[44:47], s31 offen lds
    s_add_u32 m0, s30, 20736
    s_add_u32 s31, s28, 159744
    s_add_u32 s32, s27, 106496
    s_add_u32 s34, s27, 106752
    s_waitcnt vmcnt(13)
    s_waitcnt lgkmcnt(0)
    s_barrier
    buffer_load_dwordx4 v10, s[8:11], s31 offen offset:0 lds
    buffer_load_dwordx4 v10, s[8:11], s31 offen offset:1024 lds
    buffer_load_dwordx4 v10, s[8:11], s31 offen offset:2048 lds
    s_add_u32 m0, s29, 20736
    s_nop 0
    buffer_load_dwordx4 v8, s[12:15], s32 offen lds
    s_add_u32 m0, s29, 21792
    s_nop 0
    buffer_load_dwordx4 v8, s[12:15], s34 offen lds
    s_cmp_eq_u32 s24, 10
    s_cbranch_scc1 K3_ST10
K3_STR10:
    s_add_u32 s31, s48, 36864
    s_add_u32 m0, s49, 36864
    s_nop 0
    buffer_load_dwordx4 v10, s[44:47], s31 offen lds
    s_add_u32 m0, s30, 41472
    s_add_u32 s31, s28, 172032
    s_add_u32 s32, s27, 114688
    s_add_u32 s34, s27, 114944
    s_waitcnt vmcnt(13)
    s_waitcnt lgkmcnt(0)
    s_barrier
    buffer_load_dwordx4 v10, s[8:11], s31 offen offset:0 lds
    buffer_load_dwordx4 v10, s[8:11], s31 offen offset:1024 lds
    buffer_load_dwordx4 v10, s[8:11], s31 offen offset:2048 lds
    s_add_u32 m0, s29, 41472
    s_nop 0
    buffer_load_dwordx4 v8, s[12:15], s32 offen lds
    s_add_u32 m0, s29, 42528
    s_nop 0
    buffer_load_dwordx4 v8, s[12:15], s34 offen lds
    s_cmp_eq_u32 s24, 11
    s_cbranch_scc1 K3_ST11
K3_STR11:
    s_add_u32 s31, s48, 40960
    s_add_u32 m0, s49, 40960
    s_nop 0
    buffer_load_dwordx4 v10, s[44:47], s31 offen lds
    s_add_u32 m0, s30, 62208
    s_add_u32 s31, s28, 184320
    s_add_u32 s32, s27, 122880
    s_add_u32 s34, s27, 123136
    s_waitcnt vmcnt(13)
    s_waitcnt lgkmcnt(0)
    s_barrier
    buffer_load_dwordx4 v10, s[8:11], s31 offen offset:0 lds
    buffer_load_dwordx4 v10, s[8:11], s31 offen offset:1024 lds
    buffer_load_dwordx4 v10, s[8:11], s31 offen offset:2048 lds
    s_add_u32 m0, s29, 62208
    s_nop 0
    buffer_load_dwordx4 v8, s[12:15], s32 offen lds
    s_add_u32 m0, s29, 63264
    s_nop 0
    buffer_load_dwordx4 v8, s[12:15], s34 offen lds
    s_cmp_eq_u32 s24, 12
    s_cbranch_scc1 K3_ST12
K3_STR12:
    s_add_u32 s31, s48, 45056
    s_add_u32 m0, s49, 45056
    s_nop 0
    buffer_load_dwordx4 v10, s[44:47], s31 offen lds
    s_add_u32 m0, s30, 0
    s_add_u32 s31, s28, 196608
    s_add_u32 s32, s27, 131072
    s_add_u32 s34, s27, 131328
    s_waitcnt vmcnt(13)
    s_waitcnt lgkmcnt(0)
    s_barrier
    buffer_load_dwordx4 v10, s[8:11], s31 offen offset:0 lds
    buffer_load_dwordx4 v10, s[8:11], s31 offen offset:1024 lds
    buffer_load_dwordx4 v10, s[8:11], s31 offen offset:2048 lds
    s_add_u32 m0, s29, 0
    s_nop 0
    buffer_load_dwordx4 v8, s[12:15], s32 offen lds
    s_add_u32 m0, s29, 1056
    s_nop 0
    buffer_load_dwordx4 v8, s[12:15], s34 offen lds
    s_cmp_eq_u32 s24, 13
    s_cbranch_scc1 K3_ST13
K3_STR13:
    s_add_u32 s31, s48, 49152
    s_add_u32 m0, s49, 49152
    s_nop 0
    buffer_load_dwordx4 v10, s[44:47], s31 offen lds
    s_add_u32 m0, s30, 20736
    s_add_u32 s31, s28, 208896
    s_add_u32 s32, s27, 139264
    s_add_u32 s34, s27, 139520
    s_waitcnt vmcnt(13)
    s_waitcnt lgkmcnt(0)
    s_barrier
    buffer_load_dwordx4 v10, s[8:11], s31 offen offset:0 lds
    buffer_load_dwordx4 v10, s[8:11], s31 offen offset:1024 lds
    buffer_load_dwordx4 v10, s[8:11], s31 offen offset:2048 lds
    s_add_u32 m0, s29, 20736
    s_nop 0
    buffer_load_dwordx4 v8, s[12:15], s32 offen lds
    s_add_u32 m0, s29, 21792
    s_nop 0
    buffer_load_dwordx4 v8, s[12:15], s34 offen lds
    s_cmp_eq_u32 s24, 14
    s_cbranch_scc1 K3_ST14
K3_STR14:
    s_add_u32 s31, s48, 53248
    s_add_u32 m0, s49, 53248
    s_nop 0
    buffer_load_dwordx4 v10, s[44:47], s31 offen lds
    s_add_u32 m0, s30, 41472
    s_add_u32 s31, s28, 221184
    s_add_u32 s32, s27, 147456
    s_add_u32 s34, s27, 147712
    s_waitcnt vmcnt(13)
    s_waitcnt lgkmcnt(0)
    s_barrier
    buffer_load_dwordx4 v10, s[8:11], s31 offen offset:0 lds
    buffer_load_dwordx4 v10, s[8:11], s31 offen offset:1024 lds
    buffer_load_dwordx4 v10, s[8:11], s31 offen offset:2048 lds
    s_add_u32 m0, s29, 41472
    s_nop 0
    buffer_load_dwordx4 v8, s[12:15], s32 offen lds
    s_add_u32 m0, s29, 42528
    s_nop 0
    buffer_load_dwordx4 v8, s[12:15], s34 offen lds
    s_cmp_eq_u32 s24, 15
    s_cbranch_scc1 K3_ST15
K3_STR15:
    s_add_u32 s31, s48, 57344
    s_add_u32 m0, s49, 57344
    s_nop 0
    buffer_load_dwordx4 v10, s[44:47], s31 offen lds
    s_add_u32 m0, s30, 62208
    s_add_u32 s31, s28, 233472
    s_add_u32 s32, s27, 155648
    s_add_u32 s34, s27, 155904
    s_waitcnt vmcnt(13)
    s_waitcnt lgkmcnt(0)
    s_barrier
    buffer_load_dwordx4 v10, s[8:11], s31 offen offset:0 lds
    buffer_load_dwordx4 v10, s[8:11], s31 offen offset:1024 lds
    buffer_load_dwordx4 v10, s[8:11], s31 offen offset:2048 lds
    s_add_u32 m0, s29, 62208
    s_nop 0
    buffer_load_dwordx4 v8, s[12:15], s32 offen lds
    s_add_u32 m0, s29, 63264
    s_nop 0
    buffer_load_dwordx4 v8, s[12:15], s34 offen lds
    s_cmp_eq_u32 s24, 0
    s_cbranch_scc1 K3_ST16
K3_STR16:
    s_add_u32 s31, s48, 61440
    s_add_u32 m0, s49, 61440
    s_nop 0
    buffer_load_dwordx4 v10, s[44:47], s31 offen lds
    s_waitcnt vmcnt(13)
    s_waitcnt lgkmcnt(0)
    s_barrier
    s_cmp_eq_u32 s24, 1
    s_cbranch_scc1 K3_ST17
K3_STR17:
    s_add_u32 s31, s48, 65536
    s_add_u32 m0, s49, 65536
    s_nop 0
    buffer_load_dwordx4 v10, s[44:47], s31 offen lds
    s_add_u32 s31, s48, 69632
    s_add_u32 m0, s49, 69632
    s_nop 0
    buffer_load_dwordx4 v10, s[44:47], s31 offen lds
    s_add_u32 s31, s48, 73728
    s_add_u32 m0, s49, 73728
    s_nop 0
    buffer_load_dwordx4 v10, s[44:47], s31 offen lds
    s_add_u32 s31, s48, 77824
    s_add_u32 m0, s49, 77824
    s_nop 0
    buffer_load_dwordx4 v10, s[44:47], s31 offen lds
    s_add_u32 s31, s48, 81920
    s_add_u32 m0, s49, 81920
    s_nop 0
    buffer_load_dwordx4 v10, s[44:47], s31 offen lds
    s_waitcnt vmcnt(12)
    s_waitcnt lgkmcnt(0)
    s_barrier
    s_cmp_eq_u32 s24, 2
    s_cbranch_scc1 K3_ST18
K3_STR18:
    s_add_u32 s31, s48, 86016
    s_add_u32 m0, s49, 86016
    s_nop 0
    buffer_load_dwordx4 v10, s[44:47], s31 offen lds
    s_add_u32 s31, s48, 90112
    s_add_u32 m0, s49, 90112
    s_nop 0
    buffer_load_dwordx4 v10, s[44:47], s31 offen lds
    s_add_u32 s31, s48, 94208
    s_add_u32 m0, s49, 94208
    s_nop 0
    buffer_load_dwordx4 v10, s[44:47], s31 offen lds
    s_add_u32 s31, s48, 98304
    s_add_u32 m0, s49, 98304
    s_nop 0
    buffer_load_dwordx4 v10, s[44:47], s31 offen lds
    s_add_u32 s31, s48, 102400
    s_add_u32 m0, s49, 102400
    s_nop 0
    buffer_load_dwordx4 v10, s[44:47], s31 offen lds
    s_waitcnt vmcnt(11)
    s_waitcnt lgkmcnt(0)
    s_barrier
    s_cmp_eq_u32 s24, 3
    s_cbranch_scc1 K3_ST19
K3_STR19:
    s_add_u32 s31, s48, 106496
    s_add_u32 m0, s49, 106496
    s_nop 0
    buffer_load_dwordx4 v10, s[44:47], s31 offen lds
    s_add_u32 s31, s48, 110592
    s_add_u32 m0, s49, 110592
    s_nop 0
    buffer_load_dwordx4 v10, s[44:47], s31 offen lds
    s_add_u32 s31, s48, 114688
    s_add_u32 m0, s49, 114688
    s_nop 0
    buffer_load_dwordx4 v10, s[44:47], s31 offen lds
    s_add_u32 s31, s48, 118784
    s_add_u32 m0, s49, 118784
    s_nop 0
    buffer_load_dwordx4 v10, s[44:47], s31 offen lds
    s_add_u32 s31, s48, 122880
    s_add_u32 m0, s49, 122880
    s_nop 0
    buffer_load_dwordx4 v10, s[44:47], s31 offen lds
    s_waitcnt lgkmcnt(0)
    s_barrier
    v_add_u32 v18, s49, v10
    s_add_u32 s31, s48, 126976
    s_add_u32 m0, s49, 126976
    s_nop 0
    buffer_load_dwordx4 v10, s[44:47], s31 offen lds
    s_add_u32 s31, s48, 131072
    s_add_u32 m0, s49, 131072
    s_nop 0
    buffer_load_dwordx4 v10, s[44:47], s31 offen lds
    s_add_u32 s31, s48, 135168
    s_add_u32 m0, s49, 135168
    s_nop 0
    buffer_load_dwordx4 v10, s[44:47], s31 offen lds
    s_add_u32 s31, s48, 139264
    s_add_u32 m0, s49, 139264
    s_nop 0
    buffer_load_dwordx4 v10, s[44:47], s31 offen lds
    s_add_u32 s31, s48, 143360
    s_add_u32 m0, s49, 143360
    s_nop 0
    buffer_load_dwordx4 v10, s[44:47], s31 offen lds
    s_add_u32 s31, s48, 147456
    s_add_u32 m0, s49, 147456
    s_nop 0
    buffer_load_dwordx4 v10, s[44:47], s31 offen lds
    s_add_u32 s31, s48, 151552
    s_add_u32 m0, s49, 151552
    s_nop 0
    buffer_load_dwordx4 v10, s[44:47], s31 offen lds
    s_add_u32 s31, s48, 155648
    s_add_u32 m0, s49, 155648
    s_nop 0
    buffer_load_dwordx4 v10, s[44:47], s31 offen lds
    v_mov_b32 v20, 0
    v_mov_b32 v21, 0
    v_mov_b32 v22, 0
    v_mov_b32 v23, 0
    v_lshlrev_b32 v28, 16, v112
    v_and_b32 v29, 0xffff0000, v112
    v_add_f32 v20, v20, v28
    v_fmac_f32 v21, v28, v28
    v_add_f32 v20, v20, v29
    v_fmac_f32 v21, v29, v29
    v_lshlrev_b32 v28, 16, v116
    v_and_b32 v29, 0xffff0000, v116
    v_add_f32 v22, v22, v28
    v_fmac_f32 v23, v28, v28
    v_add_f32 v22, v22, v29
    v_fmac_f32 v23, v29, v29
    v_lshlrev_b32 v28, 16, v113
    v_and_b32 v29, 0xffff0000, v113
    v_add_f32 v20, v20, v28
    v_fmac_f32 v21, v28, v28
    v_add_f32 v20, v20, v29
    v_fmac_f32 v21, v29, v29
    v_lshlrev_b32 v28, 16, v117
    v_and_b32 v29, 0xffff0000, v117
    v_add_f32 v22, v22, v28
    v_fmac_f32 v23, v28, v28
    v_add_f32 v22, v22, v29
    v_fmac_f32 v23, v29, v29
    v_lshlrev_b32 v28, 16, v114
    v_and_b32 v29, 0xffff0000, v114
    v_add_f32 v20, v20, v28
    v_fmac_f32 v21, v28, v28
    v_add_f32 v20, v20, v29
    v_fmac_f32 v21, v29, v29
    v_lshlrev_b32 v28, 16, v118
    v_and_b32 v29, 0xffff0000, v118
    v_add_f32 v22, v22, v28
    v_fmac_f32 v23, v28, v28
    v_add_f32 v22, v22, v29
    v_fmac_f32 v23, v29, v29
    v_lshlrev_b32 v28, 16, v115
    v_and_b32 v29, 0xffff0000, v115
    v_add_f32 v20, v20, v28
    v_fmac_f32 v21, v28, v28
    v_add_f32 v20, v20, v29
    v_fmac_f32 v21, v29, v29
    v_lshlrev_b32 v28, 16, v119
    v_and_b32 v29, 0xffff0000, v119
    v_add_f32 v22, v22, v28
    v_fmac_f32 v23, v28, v28
    v_add_f32 v22, v22, v29
    v_fmac_f32 v23, v29, v29
    s_nop 0
    v_permlane16_swap_b32 v20, v22
    v_permlane16_swap_b32 v21, v23
    v_add_f32 v20, v20, v22
    v_add_f32 v21, v21, v23
    v_mov_b32 v22, v20
    v_mov_b32 v23, v21
    s_nop 0
    v_permlane32_swap_b32 v20, v22
    v_permlane32_swap_b32 v21, v23
    v_add_f32 v24, v20, v22
    v_add_f32 v25, v21, v23
    s_lshl_b32 s35, s23, 10
    s_lshl_b32 s26, s24, 14
    s_add_u32 s26, s26, s35
    s_mov_b32 exec_hi, 0
    buffer_store_dwordx2 v[24:25], v13, s[36:39], s26 offen sc1
    s_mov_b32 exec_hi, -1
    s_cmp_ge_u32 s24, 4
    s_cbranch_scc1 K3_ST1D
    v_mov_b32 v20, 0
    v_mov_b32 v21, 0
    v_mov_b32 v22, 0
    v_mov_b32 v23, 0
    v_lshlrev_b32 v28, 16, v120
    v_and_b32 v29, 0xffff0000, v120
    v_add_f32 v20, v20, v28
    v_fmac_f32 v21, v28, v28
    v_add_f32 v20, v20, v29
    v_fmac_f32 v21, v29, v29
    v_lshlrev_b32 v28, 16, v124
    v_and_b32 v29, 0xffff0000, v124
    v_add_f32 v22, v22, v28
    v_fmac_f32 v23, v28, v28
    v_add_f32 v22, v22, v29
    v_fmac_f32 v23, v29, v29
    v_lshlrev_b32 v28, 16, v121
    v_and_b32 v29, 0xffff0000, v121
    v_add_f32 v20, v20, v28
    v_fmac_f32 v21, v28, v28
    v_add_f32 v20, v20, v29
    v_fmac_f32 v21, v29, v29
    v_lshlrev_b32 v28, 16, v125
    v_and_b32 v29, 0xffff0000, v125
    v_add_f32 v22, v22, v28
    v_fmac_f32 v23, v28, v28
    v_add_f32 v22, v22, v29
    v_fmac_f32 v23, v29, v29
    v_lshlrev_b32 v28, 16, v122
    v_and_b32 v29, 0xffff0000, v122
    v_add_f32 v20, v20, v28
    v_fmac_f32 v21, v28, v28
    v_add_f32 v20, v20, v29
    v_fmac_f32 v21, v29, v29
    v_lshlrev_b32 v28, 16, v126
    v_and_b32 v29, 0xffff0000, v126
    v_add_f32 v22, v22, v28
    v_fmac_f32 v23, v28, v28
    v_add_f32 v22, v22, v29
    v_fmac_f32 v23, v29, v29
    v_lshlrev_b32 v28, 16, v123
    v_and_b32 v29, 0xffff0000, v123
    v_add_f32 v20, v20, v28
    v_fmac_f32 v21, v28, v28
    v_add_f32 v20, v20, v29
    v_fmac_f32 v21, v29, v29
    v_lshlrev_b32 v28, 16, v127
    v_and_b32 v29, 0xffff0000, v127
    v_add_f32 v22, v22, v28
    v_fmac_f32 v23, v28, v28
    v_add_f32 v22, v22, v29
    v_fmac_f32 v23, v29, v29
    s_nop 0
    v_permlane16_swap_b32 v20, v22
    v_permlane16_swap_b32 v21, v23
    v_add_f32 v20, v20, v22
    v_add_f32 v21, v21, v23
    v_mov_b32 v22, v20
    v_mov_b32 v23, v21
    s_nop 0
    v_permlane32_swap_b32 v20, v22
    v_permlane32_swap_b32 v21, v23
    v_add_f32 v26, v20, v22
    v_add_f32 v27, v21, v23
    s_lshl_b32 s35, s23, 10
    s_lshl_b32 s26, s24, 14
    s_add_u32 s26, s26, s35
    s_add_u32 s26, s26, 262144
    s_mov_b32 exec_hi, 0
    buffer_store_dwordx2 v[26:27], v13, s[36:39], s26 offen sc1
    s_mov_b32 exec_hi, -1
K3_ST1D:
    s_waitcnt vmcnt(0)
    s_waitcnt vmcnt(0)
    s_barrier
    s_add_u32 s31, s48, 159744
    s_add_u32 m0, s49, 159744
    s_nop 0
    buffer_load_dwordx4 v10, s[44:47], s31 offen lds
    s_add_u32 s31, s48, 163840
    buffer_load_dwordx4 v[32:35], v10, s[44:47], s31 offen
    s_add_u32 s31, s48, 167936
    buffer_load_dwordx4 v[36:39], v10, s[44:47], s31 offen
    s_add_u32 s31, s48, 172032
    buffer_load_dwordx4 v[40:43], v10, s[44:47], s31 offen
    s_add_u32 s31, s48, 176128
    buffer_load_dwordx4 v[44:47], v10, s[44:47], s31 offen
    s_add_u32 s31, s48, 180224
    buffer_load_dwordx4 v[48:51], v10, s[44:47], s31 offen
    s_add_u32 s31, s48, 184320
    buffer_load_dwordx4 v[52:55], v10, s[44:47], s31 offen
    s_add_u32 s31, s48, 188416
    buffer_load_dwordx4 v[56:59], v10, s[44:47], s31 offen
    s_add_u32 s31, s48, 192512
    buffer_load_dwordx4 v[60:63], v10, s[44:47], s31 offen
    s_add_u32 s31, s48, 196608
    buffer_load_dwordx4 v[64:67], v10, s[44:47], s31 offen
    s_add_u32 s31, s48, 200704
    buffer_load_dwordx4 v[68:71], v10, s[44:47], s31 offen
    s_add_u32 s31, s48, 204800
    buffer_load_dwordx4 v[72:75], v10, s[44:47], s31 offen
    s_add_u32 s31, s48, 208896
    buffer_load_dwordx4 v[76:79], v10, s[44:47], s31 offen
    s_add_u32 s31, s48, 212992
    buffer_load_dwordx4 v[80:83], v10, s[44:47], s31 offen
    s_add_u32 s31, s48, 217088
    buffer_load_dwordx4 v[84:87], v10, s[44:47], s31 offen
    s_add_u32 s31, s48, 221184
    buffer_load_dwordx4 v[88:91], v10, s[44:47], s31 offen
    s_add_u32 s31, s48, 225280
    buffer_load_dwordx4 v[92:95], v10, s[44:47], s31 offen
    s_add_u32 s31, s48, 229376
    buffer_load_dwordx4 v[96:99], v10, s[44:47], s31 offen
    s_add_u32 s31, s48, 233472
    buffer_load_dwordx4 v[100:103], v10, s[44:47], s31 offen
    s_add_u32 s31, s48, 237568
    buffer_load_dwordx4 v[104:107], v10, s[44:47], s31 offen
    s_add_u32 s31, s48, 241664
    buffer_load_dwordx4 v[108:111], v10, s[44:47], s31 offen
    s_barrier
    v_add_u32 v19, 0xa000, v18
    s_barrier
    s_waitcnt vmcnt(19)
    ds_write_b128 v18, v[32:35] offset:0
    s_waitcnt vmcnt(18)
    ds_write_b128 v18, v[36:39] offset:4096
    s_waitcnt vmcnt(17)
    ds_write_b128 v18, v[40:43] offset:8192
    s_waitcnt vmcnt(16)
    ds_write_b128 v18, v[44:47] offset:12288
    s_barrier
    s_waitcnt vmcnt(15)
    ds_write_b128 v18, v[48:51] offset:16384
    s_waitcnt vmcnt(14)
    ds_write_b128 v18, v[52:55] offset:20480
    s_waitcnt vmcnt(13)
    ds_write_b128 v18, v[56:59] offset:24576
    s_waitcnt vmcnt(12)
    ds_write_b128 v18, v[60:63] offset:28672
    s_waitcnt vmcnt(11)
    ds_write_b128 v18, v[64:67] offset:32768
    s_waitcnt vmcnt(10)
    ds_write_b128 v18, v[68:71] offset:36864
    s_waitcnt vmcnt(9)
    ds_write_b128 v19, v[72:75] offset:0
    s_waitcnt vmcnt(8)
    ds_write_b128 v19, v[76:79] offset:4096
    s_waitcnt vmcnt(7)
    ds_write_b128 v19, v[80:83] offset:8192
    s_waitcnt vmcnt(6)
    ds_write_b128 v19, v[84:87] offset:12288
    s_waitcnt lgkmcnt(4)
    s_barrier
    s_waitcnt vmcnt(5)
    ds_write_b128 v19, v[88:91] offset:16384
    s_waitcnt vmcnt(4)
    ds_write_b128 v19, v[92:95] offset:20480
    s_waitcnt vmcnt(3)
    ds_write_b128 v19, v[96:99] offset:24576
    s_waitcnt vmcnt(2)
    ds_write_b128 v19, v[100:103] offset:28672
    s_waitcnt vmcnt(1)
    ds_write_b128 v19, v[104:107] offset:32768
    s_waitcnt vmcnt(0)
    ds_write_b128 v19, v[108:111] offset:36864
    s_waitcnt lgkmcnt(0)
    s_barrier
    s_endpgm
K3_ST0:
    v_add_u32 v14, 76800, v12
    ds_read_b64_tr_b16 v[112:113], v14 offset:0
    ds_read_b64_tr_b16 v[114:115], v14 offset:512
    ds_read_b64_tr_b16 v[116:117], v14 offset:32
    ds_read_b64_tr_b16 v[118:119], v14 offset:544
    s_branch K3_STR0
K3_ST1:
    v_add_u32 v14, 97536, v12
    ds_read_b64_tr_b16 v[112:113], v14 offset:0
    ds_read_b64_tr_b16 v[114:115], v14 offset:512
    ds_read_b64_tr_b16 v[116:117], v14 offset:32
    ds_read_b64_tr_b16 v[118:119], v14 offset:544
    s_branch K3_STR1
K3_ST2:
    v_add_u32 v14, 118272, v12
    ds_read_b64_tr_b16 v[112:113], v14 offset:0
    ds_read_b64_tr_b16 v[114:115], v14 offset:512
    ds_read_b64_tr_b16 v[116:117], v14 offset:32
    ds_read_b64_tr_b16 v[118:119], v14 offset:544
    s_branch K3_STR2
K3_ST3:
    v_add_u32 v14, 139008, v12
    ds_read_b64_tr_b16 v[112:113], v14 offset:0
    ds_read_b64_tr_b16 v[114:115], v14 offset:512
    ds_read_b64_tr_b16 v[116:117], v14 offset:32
    ds_read_b64_tr_b16 v[118:119], v14 offset:544
    s_branch K3_STR3
K3_ST4:
    v_add_u32 v14, 76800, v12
    ds_read_b64_tr_b16 v[112:113], v14 offset:0
    ds_read_b64_tr_b16 v[114:115], v14 offset:512
    ds_read_b64_tr_b16 v[116:117], v14 offset:32
    ds_read_b64_tr_b16 v[118:119], v14 offset:544
    s_branch K3_STR4
K3_ST5:
    v_add_u32 v14, 97536, v12
    ds_read_b64_tr_b16 v[112:113], v14 offset:0
    ds_read_b64_tr_b16 v[114:115], v14 offset:512
    ds_read_b64_tr_b16 v[116:117], v14 offset:32
    ds_read_b64_tr_b16 v[118:119], v14 offset:544
    s_branch K3_STR5
K3_ST6:
    v_add_u32 v14, 118272, v12
    ds_read_b64_tr_b16 v[112:113], v14 offset:0
    ds_read_b64_tr_b16 v[114:115], v14 offset:512
    ds_read_b64_tr_b16 v[116:117], v14 offset:32
    ds_read_b64_tr_b16 v[118:119], v14 offset:544
    s_branch K3_STR6
K3_ST7:
    v_add_u32 v14, 139008, v12
    ds_read_b64_tr_b16 v[112:113], v14 offset:0
    ds_read_b64_tr_b16 v[114:115], v14 offset:512
    ds_read_b64_tr_b16 v[116:117], v14 offset:32
    ds_read_b64_tr_b16 v[118:119], v14 offset:544
    s_branch K3_STR7
K3_ST8:
    v_add_u32 v14, 76800, v12
    ds_read_b64_tr_b16 v[112:113], v14 offset:0
    ds_read_b64_tr_b16 v[114:115], v14 offset:512
    ds_read_b64_tr_b16 v[116:117], v14 offset:32
    ds_read_b64_tr_b16 v[118:119], v14 offset:544
    s_branch K3_STR8
K3_ST9:
    v_add_u32 v14, 97536, v12
    ds_read_b64_tr_b16 v[112:113], v14 offset:0
    ds_read_b64_tr_b16 v[114:115], v14 offset:512
    ds_read_b64_tr_b16 v[116:117], v14 offset:32
    ds_read_b64_tr_b16 v[118:119], v14 offset:544
    s_branch K3_STR9
K3_ST10:
    v_add_u32 v14, 118272, v12
    ds_read_b64_tr_b16 v[112:113], v14 offset:0
    ds_read_b64_tr_b16 v[114:115], v14 offset:512
    ds_read_b64_tr_b16 v[116:117], v14 offset:32
    ds_read_b64_tr_b16 v[118:119], v14 offset:544
    s_branch K3_STR10
K3_ST11:
    v_add_u32 v14, 139008, v12
    ds_read_b64_tr_b16 v[112:113], v14 offset:0
    ds_read_b64_tr_b16 v[114:115], v14 offset:512
    ds_read_b64_tr_b16 v[116:117], v14 offset:32
    ds_read_b64_tr_b16 v[118:119], v14 offset:544
    s_branch K3_STR11
K3_ST12:
    v_add_u32 v14, 76800, v12
    ds_read_b64_tr_b16 v[112:113], v14 offset:0
    ds_read_b64_tr_b16 v[114:115], v14 offset:512
    ds_read_b64_tr_b16 v[116:117], v14 offset:32
    ds_read_b64_tr_b16 v[118:119], v14 offset:544
    s_branch K3_STR12
K3_ST13:
    v_add_u32 v14, 97536, v12
    ds_read_b64_tr_b16 v[112:113], v14 offset:0
    ds_read_b64_tr_b16 v[114:115], v14 offset:512
    ds_read_b64_tr_b16 v[116:117], v14 offset:32
    ds_read_b64_tr_b16 v[118:119], v14 offset:544
    s_branch K3_STR13
K3_ST14:
    v_add_u32 v14, 118272, v12
    ds_read_b64_tr_b16 v[112:113], v14 offset:0
    ds_read_b64_tr_b16 v[114:115], v14 offset:512
    ds_read_b64_tr_b16 v[116:117], v14 offset:32
    ds_read_b64_tr_b16 v[118:119], v14 offset:544
    s_branch K3_STR14
K3_ST15:
    v_add_u32 v14, 139008, v12
    ds_read_b64_tr_b16 v[112:113], v14 offset:0
    ds_read_b64_tr_b16 v[114:115], v14 offset:512
    ds_read_b64_tr_b16 v[116:117], v14 offset:32
    ds_read_b64_tr_b16 v[118:119], v14 offset:544
    s_branch K3_STR15
K3_ST16:
    v_add_u32 v14, 76800, v12
    ds_read_b64_tr_b16 v[120:121], v14 offset:0
    ds_read_b64_tr_b16 v[122:123], v14 offset:512
    ds_read_b64_tr_b16 v[124:125], v14 offset:32
    ds_read_b64_tr_b16 v[126:127], v14 offset:544
    s_branch K3_STR16
K3_ST17:
    v_add_u32 v14, 97536, v12
    ds_read_b64_tr_b16 v[120:121], v14 offset:0
    ds_read_b64_tr_b16 v[122:123], v14 offset:512
    ds_read_b64_tr_b16 v[124:125], v14 offset:32
    ds_read_b64_tr_b16 v[126:127], v14 offset:544
    s_branch K3_STR17
K3_ST18:
    v_add_u32 v14, 118272, v12
    ds_read_b64_tr_b16 v[120:121], v14 offset:0
    ds_read_b64_tr_b16 v[122:123], v14 offset:512
    ds_read_b64_tr_b16 v[124:125], v14 offset:32
    ds_read_b64_tr_b16 v[126:127], v14 offset:544
    s_branch K3_STR18
K3_ST19:
    v_add_u32 v14, 139008, v12
    ds_read_b64_tr_b16 v[120:121], v14 offset:0
    ds_read_b64_tr_b16 v[122:123], v14 offset:512
    ds_read_b64_tr_b16 v[124:125], v14 offset:32
    ds_read_b64_tr_b16 v[126:127], v14 offset:544
    s_branch K3_STR19
K3_COMP:
    s_cmp_ge_u32 s2, 16
    s_cbranch_scc1 K3_NOPF
    v_lshlrev_b32 v1, 7, v0
    s_getpc_b64 s[64:65]
K3_PFH:
    s_sub_u32 s64, s64, K3_PFH-k3_kernel
    s_subb_u32 s65, s65, 0
    s_mov_b32 s66, CODE_END-k3_kernel
    s_mov_b32 s67, 0x20000
    buffer_load_dword v240, v1, s[64:67], 0 offen
K3_NOPF:
    s_and_b32 s25, s22, 1
    s_lshr_b32 s26, s22, 1
    v_bfe_u32 v3, v2, 2, 3
    v_mul_u32_u24 v4, 1056, v3
    v_lshrrev_b32 v3, 5, v2
    v_lshl_add_u32 v4, v3, 8, v4
    v_and_b32 v3, 3, v2
    v_lshl_add_u32 v4, v3, 3, v4
    s_lshl_b32 s29, s25, 7
    s_add_u32 s29, s29, 76800
    v_add_u32 v4, s29, v4
    v_add_u32 v5, 41472, v4
    s_mul_i32 s29, s26, 3072
    s_add_u32 s29, s29, 85248
    v_lshl_add_u32 v6, v2, 4, s29
    v_add_u32 v7, 41472, v6
    v_lshlrev_b32 v8, 4, v2
    v_bfe_u32 v3, v2, 4, 1
    v_mul_u32_u24 v9, 49152, v3
    v_lshrrev_b32 v3, 5, v2
    v_lshl_add_u32 v9, v3, 8, v9
    v_and_b32 v3, 15, v2
    v_lshl_add_u32 v9, v3, 4, v9
    s_waitcnt lgkmcnt(0)
    s_add_u32 s12, s16, 0xa00000
    s_addc_u32 s13, s17, 0
    s_mov_b32 s14, 0x600000
    s_mov_b32 s15, 0x20000
    s_add_u32 s52, s16, 0x1100000
    s_addc_u32 s53, s17, 0
    s_mov_b32 s54, 0x28000
    s_mov_b32 s55, 0x20000
    s_barrier
    ds_read_b64_tr_b16 v[136:137], v4 offset:0
    ds_read_b64_tr_b16 v[138:139], v4 offset:512
    ds_read_b128 v[112:115], v6 offset:0
    ds_read_b128 v[116:119], v6 offset:1024
    ds_read_b128 v[120:123], v6 offset:2048
    ds_read_b128 v[124:127], v6 offset:6144
    ds_read_b128 v[128:131], v6 offset:7168
    ds_read_b128 v[132:135], v6 offset:8192
    ds_read_b64_tr_b16 v[140:141], v4 offset:32
    ds_read_b64_tr_b16 v[142:143], v4 offset:544
    ds_read_b64_tr_b16 v[144:145], v4 offset:64
    ds_read_b64_tr_b16 v[146:147], v4 offset:576
    ds_read_b64_tr_b16 v[148:149], v4 offset:96
    ds_read_b64_tr_b16 v[150:151], v4 offset:608
    s_lshl_b32 s27, s23, 1
    s_add_u32 s30, s27, s25
    s_mul_i32 s27, s30, 196608
    s_mul_i32 s28, s24, 3072
    s_add_u32 s27, s27, s28
    s_lshl_b32 s28, s26, 11
    s_lshl_b32 s29, s26, 9
    s_add_u32 s29, s29, 1024
    s_add_u32 s28, s28, s27
    s_add_u32 s29, s29, s27
    s_waitcnt lgkmcnt(11)
    v_mfma_f32_16x16x32_bf16 v[16:19], v[112:115], v[136:139], 0
    s_waitcnt lgkmcnt(10)
    v_mfma_f32_16x16x32_bf16 v[20:23], v[116:119], v[136:139], 0
    s_waitcnt lgkmcnt(9)
    v_mfma_f32_16x16x32_bf16 v[24:27], v[120:123], v[136:139], 0
    s_waitcnt lgkmcnt(8)
    v_mfma_f32_16x16x32_bf16 v[28:31], v[124:127], v[136:139], 0
    s_waitcnt lgkmcnt(7)
    v_mfma_f32_16x16x32_bf16 v[32:35], v[128:131], v[136:139], 0
    s_waitcnt lgkmcnt(6)
    v_mfma_f32_16x16x32_bf16 v[36:39], v[132:135], v[136:139], 0
    s_waitcnt lgkmcnt(0)
    v_mfma_f32_16x16x32_bf16 v[60:63], v[132:135], v[140:143], 0
    s_barrier
    ds_read_b64_tr_b16 v[176:177], v4 offset:20736
    v_mfma_f32_16x16x32_bf16 v[56:59], v[128:131], v[140:143], 0
    ds_read_b64_tr_b16 v[178:179], v4 offset:21248
    v_mfma_f32_16x16x32_bf16 v[52:55], v[124:127], v[140:143], 0
    ds_read_b128 v[152:155], v6 offset:20736
    v_mfma_f32_16x16x32_bf16 v[48:51], v[120:123], v[140:143], 0
    ds_read_b128 v[156:159], v6 offset:21760
    v_mfma_f32_16x16x32_bf16 v[44:47], v[116:119], v[140:143], 0
    ds_read_b128 v[160:163], v6 offset:22784
    v_mfma_f32_16x16x32_bf16 v[40:43], v[112:115], v[140:143], 0
    ds_read_b128 v[164:167], v6 offset:26880
    v_mfma_f32_16x16x32_bf16 v[64:67], v[112:115], v[144:147], 0
    ds_read_b128 v[168:171], v6 offset:27904
    v_mfma_f32_16x16x32_bf16 v[68:71], v[116:119], v[144:147], 0
    ds_read_b128 v[172:175], v6 offset:28928
    v_mfma_f32_16x16x32_bf16 v[72:75], v[120:123], v[144:147], 0
    ds_read_b64_tr_b16 v[180:181], v4 offset:20768
    v_mfma_f32_16x16x32_bf16 v[76:79], v[124:127], v[144:147], 0
    ds_read_b64_tr_b16 v[182:183], v4 offset:21280
    v_mfma_f32_16x16x32_bf16 v[80:83], v[128:131], v[144:147], 0
    ds_read_b64_tr_b16 v[184:185], v4 offset:20800
    v_mfma_f32_16x16x32_bf16 v[84:87], v[132:135], v[144:147], 0
    ds_read_b64_tr_b16 v[186:187], v4 offset:21312
    v_mfma_f32_16x16x32_bf16 v[108:111], v[132:135], v[148:151], 0
    ds_read_b64_tr_b16 v[188:189], v4 offset:20832
    v_mfma_f32_16x16x32_bf16 v[104:107], v[128:131], v[148:151], 0
    ds_read_b64_tr_b16 v[190:191], v4 offset:21344
    v_mfma_f32_16x16x32_bf16 v[100:103], v[124:127], v[148:151], 0
    v_mfma_f32_16x16x32_bf16 v[96:99], v[120:123], v[148:151], 0
    v_mfma_f32_16x16x32_bf16 v[92:95], v[116:119], v[148:151], 0
    v_mfma_f32_16x16x32_bf16 v[88:91], v[112:115], v[148:151], 0
    s_waitcnt lgkmcnt(11)
    v_mfma_f32_16x16x32_bf16 v[16:19], v[152:155], v[176:179], v[16:19]
    s_waitcnt lgkmcnt(10)
    v_mfma_f32_16x16x32_bf16 v[20:23], v[156:159], v[176:179], v[20:23]
    s_waitcnt lgkmcnt(9)
    v_mfma_f32_16x16x32_bf16 v[24:27], v[160:163], v[176:179], v[24:27]
    s_waitcnt lgkmcnt(8)
    v_mfma_f32_16x16x32_bf16 v[28:31], v[164:167], v[176:179], v[28:31]
    s_waitcnt lgkmcnt(7)
    v_mfma_f32_16x16x32_bf16 v[32:35], v[168:171], v[176:179], v[32:35]
    s_waitcnt lgkmcnt(6)
    v_mfma_f32_16x16x32_bf16 v[36:39], v[172:175], v[176:179], v[36:39]
    s_waitcnt lgkmcnt(0)
    v_mfma_f32_16x16x32_bf16 v[60:63], v[172:175], v[180:183], v[60:63]
    s_barrier
    ds_read_b64_tr_b16 v[136:137], v5 offset:0
    v_mfma_f32_16x16x32_bf16 v[56:59], v[168:171], v[180:183], v[56:59]
    ds_read_b64_tr_b16 v[138:139], v5 offset:512
    v_mfma_f32_16x16x32_bf16 v[52:55], v[164:167], v[180:183], v[52:55]
    ds_read_b128 v[112:115], v7 offset:0
    v_mfma_f32_16x16x32_bf16 v[48:51], v[160:163], v[180:183], v[48:51]
    ds_read_b128 v[116:119], v7 offset:1024
    v_mfma_f32_16x16x32_bf16 v[44:47], v[156:159], v[180:183], v[44:47]
    ds_read_b128 v[120:123], v7 offset:2048
    v_mfma_f32_16x16x32_bf16 v[40:43], v[152:155], v[180:183], v[40:43]
    ds_read_b128 v[124:127], v7 offset:6144
    v_mfma_f32_16x16x32_bf16 v[64:67], v[152:155], v[184:187], v[64:67]
    ds_read_b128 v[128:131], v7 offset:7168
    v_mfma_f32_16x16x32_bf16 v[68:71], v[156:159], v[184:187], v[68:71]
    ds_read_b128 v[132:135], v7 offset:8192
    v_mfma_f32_16x16x32_bf16 v[72:75], v[160:163], v[184:187], v[72:75]
    ds_read_b64_tr_b16 v[140:141], v5 offset:32
    v_mfma_f32_16x16x32_bf16 v[76:79], v[164:167], v[184:187], v[76:79]
    ds_read_b64_tr_b16 v[142:143], v5 offset:544
    v_mfma_f32_16x16x32_bf16 v[80:83], v[168:171], v[184:187], v[80:83]
    ds_read_b64_tr_b16 v[144:145], v5 offset:64
    v_mfma_f32_16x16x32_bf16 v[84:87], v[172:175], v[184:187], v[84:87]
    ds_read_b64_tr_b16 v[146:147], v5 offset:576
    v_mfma_f32_16x16x32_bf16 v[108:111], v[172:175], v[188:191], v[108:111]
    ds_read_b64_tr_b16 v[148:149], v5 offset:96
    v_mfma_f32_16x16x32_bf16 v[104:107], v[168:171], v[188:191], v[104:107]
    ds_read_b64_tr_b16 v[150:151], v5 offset:608
    v_mfma_f32_16x16x32_bf16 v[100:103], v[164:167], v[188:191], v[100:103]
    v_mfma_f32_16x16x32_bf16 v[96:99], v[160:163], v[188:191], v[96:99]
    v_mfma_f32_16x16x32_bf16 v[92:95], v[156:159], v[188:191], v[92:95]
    v_mfma_f32_16x16x32_bf16 v[88:91], v[152:155], v[188:191], v[88:91]
    s_waitcnt lgkmcnt(11)
    v_mfma_f32_16x16x32_bf16 v[16:19], v[112:115], v[136:139], v[16:19]
    s_waitcnt lgkmcnt(10)
    v_mfma_f32_16x16x32_bf16 v[20:23], v[116:119], v[136:139], v[20:23]
    s_waitcnt lgkmcnt(9)
    v_mfma_f32_16x16x32_bf16 v[24:27], v[120:123], v[136:139], v[24:27]
    s_waitcnt lgkmcnt(8)
    v_mfma_f32_16x16x32_bf16 v[28:31], v[124:127], v[136:139], v[28:31]
    s_waitcnt lgkmcnt(7)
    v_mfma_f32_16x16x32_bf16 v[32:35], v[128:131], v[136:139], v[32:35]
    s_waitcnt lgkmcnt(6)
    v_mfma_f32_16x16x32_bf16 v[36:39], v[132:135], v[136:139], v[36:39]
    s_waitcnt lgkmcnt(0)
    v_mfma_f32_16x16x32_bf16 v[60:63], v[132:135], v[140:143], v[60:63]
    s_barrier
    ds_read_b64_tr_b16 v[176:177], v5 offset:20736
    v_mfma_f32_16x16x32_bf16 v[56:59], v[128:131], v[140:143], v[56:59]
    ds_read_b64_tr_b16 v[178:179], v5 offset:21248
    v_mfma_f32_16x16x32_bf16 v[52:55], v[124:127], v[140:143], v[52:55]
    ds_read_b128 v[152:155], v7 offset:20736
    v_mfma_f32_16x16x32_bf16 v[48:51], v[120:123], v[140:143], v[48:51]
    ds_read_b128 v[156:159], v7 offset:21760
    v_mfma_f32_16x16x32_bf16 v[44:47], v[116:119], v[140:143], v[44:47]
    ds_read_b128 v[160:163], v7 offset:22784
    v_mfma_f32_16x16x32_bf16 v[40:43], v[112:115], v[140:143], v[40:43]
    ds_read_b128 v[164:167], v7 offset:26880
    v_mfma_f32_16x16x32_bf16 v[64:67], v[112:115], v[144:147], v[64:67]
    ds_read_b128 v[168:171], v7 offset:27904
    v_mfma_f32_16x16x32_bf16 v[68:71], v[116:119], v[144:147], v[68:71]
    ds_read_b128 v[172:175], v7 offset:28928
    v_mfma_f32_16x16x32_bf16 v[72:75], v[120:123], v[144:147], v[72:75]
    ds_read_b64_tr_b16 v[180:181], v5 offset:20768
    v_mfma_f32_16x16x32_bf16 v[76:79], v[124:127], v[144:147], v[76:79]
    ds_read_b64_tr_b16 v[182:183], v5 offset:21280
    v_mfma_f32_16x16x32_bf16 v[80:83], v[128:131], v[144:147], v[80:83]
    ds_read_b64_tr_b16 v[184:185], v5 offset:20800
    v_mfma_f32_16x16x32_bf16 v[84:87], v[132:135], v[144:147], v[84:87]
    ds_read_b64_tr_b16 v[186:187], v5 offset:21312
    v_mfma_f32_16x16x32_bf16 v[108:111], v[132:135], v[148:151], v[108:111]
    ds_read_b64_tr_b16 v[188:189], v5 offset:20832
    v_mfma_f32_16x16x32_bf16 v[104:107], v[128:131], v[148:151], v[104:107]
    ds_read_b64_tr_b16 v[190:191], v5 offset:21344
    v_mfma_f32_16x16x32_bf16 v[100:103], v[124:127], v[148:151], v[100:103]
    v_mfma_f32_16x16x32_bf16 v[96:99], v[120:123], v[148:151], v[96:99]
    v_mfma_f32_16x16x32_bf16 v[92:95], v[116:119], v[148:151], v[92:95]
    v_mfma_f32_16x16x32_bf16 v[88:91], v[112:115], v[148:151], v[88:91]
    s_waitcnt lgkmcnt(11)
    v_mfma_f32_16x16x32_bf16 v[16:19], v[152:155], v[176:179], v[16:19]
    s_waitcnt lgkmcnt(10)
    v_mfma_f32_16x16x32_bf16 v[20:23], v[156:159], v[176:179], v[20:23]
    s_waitcnt lgkmcnt(9)
    v_mfma_f32_16x16x32_bf16 v[24:27], v[160:163], v[176:179], v[24:27]
    s_waitcnt lgkmcnt(8)
    v_mfma_f32_16x16x32_bf16 v[28:31], v[164:167], v[176:179], v[28:31]
    s_waitcnt lgkmcnt(7)
    v_mfma_f32_16x16x32_bf16 v[32:35], v[168:171], v[176:179], v[32:35]
    s_waitcnt lgkmcnt(6)
    v_mfma_f32_16x16x32_bf16 v[36:39], v[172:175], v[176:179], v[36:39]
    s_waitcnt lgkmcnt(0)
    v_mfma_f32_16x16x32_bf16 v[60:63], v[172:175], v[180:183], v[60:63]
    s_barrier
    ds_read_b64_tr_b16 v[136:137], v4 offset:0
    v_mfma_f32_16x16x32_bf16 v[56:59], v[168:171], v[180:183], v[56:59]
    ds_read_b64_tr_b16 v[138:139], v4 offset:512
    v_mfma_f32_16x16x32_bf16 v[52:55], v[164:167], v[180:183], v[52:55]
    ds_read_b128 v[112:115], v6 offset:0
    v_mfma_f32_16x16x32_bf16 v[48:51], v[160:163], v[180:183], v[48:51]
    ds_read_b128 v[116:119], v6 offset:1024
    v_mfma_f32_16x16x32_bf16 v[44:47], v[156:159], v[180:183], v[44:47]
    ds_read_b128 v[120:123], v6 offset:2048
    v_mfma_f32_16x16x32_bf16 v[40:43], v[152:155], v[180:183], v[40:43]
    ds_read_b128 v[124:127], v6 offset:6144
    v_mfma_f32_16x16x32_bf16 v[64:67], v[152:155], v[184:187], v[64:67]
    ds_read_b128 v[128:131], v6 offset:7168
    v_mfma_f32_16x16x32_bf16 v[68:71], v[156:159], v[184:187], v[68:71]
    ds_read_b128 v[132:135], v6 offset:8192
    v_mfma_f32_16x16x32_bf16 v[72:75], v[160:163], v[184:187], v[72:75]
    ds_read_b64_tr_b16 v[140:141], v4 offset:32
    v_mfma_f32_16x16x32_bf16 v[76:79], v[164:167], v[184:187], v[76:79]
    ds_read_b64_tr_b16 v[142:143], v4 offset:544
    v_mfma_f32_16x16x32_bf16 v[80:83], v[168:171], v[184:187], v[80:83]
    ds_read_b64_tr_b16 v[144:145], v4 offset:64
    v_mfma_f32_16x16x32_bf16 v[84:87], v[172:175], v[184:187], v[84:87]
    ds_read_b64_tr_b16 v[146:147], v4 offset:576
    v_mfma_f32_16x16x32_bf16 v[108:111], v[172:175], v[188:191], v[108:111]
    ds_read_b64_tr_b16 v[148:149], v4 offset:96
    v_mfma_f32_16x16x32_bf16 v[104:107], v[168:171], v[188:191], v[104:107]
    ds_read_b64_tr_b16 v[150:151], v4 offset:608
    v_mfma_f32_16x16x32_bf16 v[100:103], v[164:167], v[188:191], v[100:103]
    v_mfma_f32_16x16x32_bf16 v[96:99], v[160:163], v[188:191], v[96:99]
    v_mfma_f32_16x16x32_bf16 v[92:95], v[156:159], v[188:191], v[92:95]
    v_mfma_f32_16x16x32_bf16 v[88:91], v[152:155], v[188:191], v[88:91]
    s_waitcnt lgkmcnt(11)
    v_mfma_f32_16x16x32_bf16 v[16:19], v[112:115], v[136:139], v[16:19]
    s_waitcnt lgkmcnt(10)
    v_mfma_f32_16x16x32_bf16 v[20:23], v[116:119], v[136:139], v[20:23]
    s_waitcnt lgkmcnt(9)
    v_mfma_f32_16x16x32_bf16 v[24:27], v[120:123], v[136:139], v[24:27]
    s_waitcnt lgkmcnt(8)
    v_mfma_f32_16x16x32_bf16 v[28:31], v[124:127], v[136:139], v[28:31]
    s_waitcnt lgkmcnt(7)
    v_mfma_f32_16x16x32_bf16 v[32:35], v[128:131], v[136:139], v[32:35]
    s_waitcnt lgkmcnt(6)
    v_mfma_f32_16x16x32_bf16 v[36:39], v[132:135], v[136:139], v[36:39]
    s_waitcnt lgkmcnt(0)
    v_mfma_f32_16x16x32_bf16 v[60:63], v[132:135], v[140:143], v[60:63]
    s_barrier
    ds_read_b64_tr_b16 v[176:177], v4 offset:20736
    v_mfma_f32_16x16x32_bf16 v[56:59], v[128:131], v[140:143], v[56:59]
    ds_read_b64_tr_b16 v[178:179], v4 offset:21248
    v_mfma_f32_16x16x32_bf16 v[52:55], v[124:127], v[140:143], v[52:55]
    ds_read_b128 v[152:155], v6 offset:20736
    v_mfma_f32_16x16x32_bf16 v[48:51], v[120:123], v[140:143], v[48:51]
    ds_read_b128 v[156:159], v6 offset:21760
    v_mfma_f32_16x16x32_bf16 v[44:47], v[116:119], v[140:143], v[44:47]
    ds_read_b128 v[160:163], v6 offset:22784
    v_mfma_f32_16x16x32_bf16 v[40:43], v[112:115], v[140:143], v[40:43]
    ds_read_b128 v[164:167], v6 offset:26880
    v_mfma_f32_16x16x32_bf16 v[64:67], v[112:115], v[144:147], v[64:67]
    ds_read_b128 v[168:171], v6 offset:27904
    v_mfma_f32_16x16x32_bf16 v[68:71], v[116:119], v[144:147], v[68:71]
    ds_read_b128 v[172:175], v6 offset:28928
    v_mfma_f32_16x16x32_bf16 v[72:75], v[120:123], v[144:147], v[72:75]
    ds_read_b64_tr_b16 v[180:181], v4 offset:20768
    v_mfma_f32_16x16x32_bf16 v[76:79], v[124:127], v[144:147], v[76:79]
    ds_read_b64_tr_b16 v[182:183], v4 offset:21280
    v_mfma_f32_16x16x32_bf16 v[80:83], v[128:131], v[144:147], v[80:83]
    ds_read_b64_tr_b16 v[184:185], v4 offset:20800
    v_mfma_f32_16x16x32_bf16 v[84:87], v[132:135], v[144:147], v[84:87]
    ds_read_b64_tr_b16 v[186:187], v4 offset:21312
    v_mfma_f32_16x16x32_bf16 v[108:111], v[132:135], v[148:151], v[108:111]
    ds_read_b64_tr_b16 v[188:189], v4 offset:20832
    v_mfma_f32_16x16x32_bf16 v[104:107], v[128:131], v[148:151], v[104:107]
    ds_read_b64_tr_b16 v[190:191], v4 offset:21344
    v_mfma_f32_16x16x32_bf16 v[100:103], v[124:127], v[148:151], v[100:103]
    v_mfma_f32_16x16x32_bf16 v[96:99], v[120:123], v[148:151], v[96:99]
    v_mfma_f32_16x16x32_bf16 v[92:95], v[116:119], v[148:151], v[92:95]
    v_mfma_f32_16x16x32_bf16 v[88:91], v[112:115], v[148:151], v[88:91]
    s_waitcnt lgkmcnt(11)
    v_mfma_f32_16x16x32_bf16 v[16:19], v[152:155], v[176:179], v[16:19]
    s_waitcnt lgkmcnt(10)
    v_mfma_f32_16x16x32_bf16 v[20:23], v[156:159], v[176:179], v[20:23]
    s_waitcnt lgkmcnt(9)
    v_mfma_f32_16x16x32_bf16 v[24:27], v[160:163], v[176:179], v[24:27]
    s_waitcnt lgkmcnt(8)
    v_mfma_f32_16x16x32_bf16 v[28:31], v[164:167], v[176:179], v[28:31]
    s_waitcnt lgkmcnt(7)
    v_mfma_f32_16x16x32_bf16 v[32:35], v[168:171], v[176:179], v[32:35]
    s_waitcnt lgkmcnt(6)
    v_mfma_f32_16x16x32_bf16 v[36:39], v[172:175], v[176:179], v[36:39]
    s_waitcnt lgkmcnt(0)
    v_mfma_f32_16x16x32_bf16 v[60:63], v[172:175], v[180:183], v[60:63]
    s_barrier
    ds_read_b64_tr_b16 v[136:137], v5 offset:0
    v_mfma_f32_16x16x32_bf16 v[56:59], v[168:171], v[180:183], v[56:59]
    ds_read_b64_tr_b16 v[138:139], v5 offset:512
    v_mfma_f32_16x16x32_bf16 v[52:55], v[164:167], v[180:183], v[52:55]
    ds_read_b128 v[112:115], v7 offset:0
    v_mfma_f32_16x16x32_bf16 v[48:51], v[160:163], v[180:183], v[48:51]
    ds_read_b128 v[116:119], v7 offset:1024
    v_mfma_f32_16x16x32_bf16 v[44:47], v[156:159], v[180:183], v[44:47]
    ds_read_b128 v[120:123], v7 offset:2048
    v_mfma_f32_16x16x32_bf16 v[40:43], v[152:155], v[180:183], v[40:43]
    ds_read_b128 v[124:127], v7 offset:6144
    v_mfma_f32_16x16x32_bf16 v[64:67], v[152:155], v[184:187], v[64:67]
    ds_read_b128 v[128:131], v7 offset:7168
    v_mfma_f32_16x16x32_bf16 v[68:71], v[156:159], v[184:187], v[68:71]
    ds_read_b128 v[132:135], v7 offset:8192
    v_mfma_f32_16x16x32_bf16 v[72:75], v[160:163], v[184:187], v[72:75]
    ds_read_b64_tr_b16 v[140:141], v5 offset:32
    v_mfma_f32_16x16x32_bf16 v[76:79], v[164:167], v[184:187], v[76:79]
    ds_read_b64_tr_b16 v[142:143], v5 offset:544
    v_mfma_f32_16x16x32_bf16 v[80:83], v[168:171], v[184:187], v[80:83]
    ds_read_b64_tr_b16 v[144:145], v5 offset:64
    v_mfma_f32_16x16x32_bf16 v[84:87], v[172:175], v[184:187], v[84:87]
    ds_read_b64_tr_b16 v[146:147], v5 offset:576
    v_mfma_f32_16x16x32_bf16 v[108:111], v[172:175], v[188:191], v[108:111]
    ds_read_b64_tr_b16 v[148:149], v5 offset:96
    v_mfma_f32_16x16x32_bf16 v[104:107], v[168:171], v[188:191], v[104:107]
    ds_read_b64_tr_b16 v[150:151], v5 offset:608
    v_mfma_f32_16x16x32_bf16 v[100:103], v[164:167], v[188:191], v[100:103]
    v_mfma_f32_16x16x32_bf16 v[96:99], v[160:163], v[188:191], v[96:99]
    v_mfma_f32_16x16x32_bf16 v[92:95], v[156:159], v[188:191], v[92:95]
    v_mfma_f32_16x16x32_bf16 v[88:91], v[152:155], v[188:191], v[88:91]
    s_waitcnt lgkmcnt(11)
    v_mfma_f32_16x16x32_bf16 v[16:19], v[112:115], v[136:139], v[16:19]
    s_waitcnt lgkmcnt(10)
    v_mfma_f32_16x16x32_bf16 v[20:23], v[116:119], v[136:139], v[20:23]
    s_waitcnt lgkmcnt(9)
    v_mfma_f32_16x16x32_bf16 v[24:27], v[120:123], v[136:139], v[24:27]
    s_waitcnt lgkmcnt(8)
    v_mfma_f32_16x16x32_bf16 v[28:31], v[124:127], v[136:139], v[28:31]
    s_waitcnt lgkmcnt(7)
    v_mfma_f32_16x16x32_bf16 v[32:35], v[128:131], v[136:139], v[32:35]
    s_waitcnt lgkmcnt(6)
    v_mfma_f32_16x16x32_bf16 v[36:39], v[132:135], v[136:139], v[36:39]
    s_waitcnt lgkmcnt(0)
    v_mfma_f32_16x16x32_bf16 v[60:63], v[132:135], v[140:143], v[60:63]
    s_barrier
    ds_read_b64_tr_b16 v[176:177], v5 offset:20736
    v_mfma_f32_16x16x32_bf16 v[56:59], v[128:131], v[140:143], v[56:59]
    ds_read_b64_tr_b16 v[178:179], v5 offset:21248
    v_mfma_f32_16x16x32_bf16 v[52:55], v[124:127], v[140:143], v[52:55]
    ds_read_b128 v[152:155], v7 offset:20736
    v_mfma_f32_16x16x32_bf16 v[48:51], v[120:123], v[140:143], v[48:51]
    ds_read_b128 v[156:159], v7 offset:21760
    v_mfma_f32_16x16x32_bf16 v[44:47], v[116:119], v[140:143], v[44:47]
    ds_read_b128 v[160:163], v7 offset:22784
    v_mfma_f32_16x16x32_bf16 v[40:43], v[112:115], v[140:143], v[40:43]
    ds_read_b128 v[164:167], v7 offset:26880
    v_mfma_f32_16x16x32_bf16 v[64:67], v[112:115], v[144:147], v[64:67]
    ds_read_b128 v[168:171], v7 offset:27904
    v_mfma_f32_16x16x32_bf16 v[68:71], v[116:119], v[144:147], v[68:71]
    ds_read_b128 v[172:175], v7 offset:28928
    v_mfma_f32_16x16x32_bf16 v[72:75], v[120:123], v[144:147], v[72:75]
    ds_read_b64_tr_b16 v[180:181], v5 offset:20768
    v_mfma_f32_16x16x32_bf16 v[76:79], v[124:127], v[144:147], v[76:79]
    ds_read_b64_tr_b16 v[182:183], v5 offset:21280
    v_mfma_f32_16x16x32_bf16 v[80:83], v[128:131], v[144:147], v[80:83]
    ds_read_b64_tr_b16 v[184:185], v5 offset:20800
    v_mfma_f32_16x16x32_bf16 v[84:87], v[132:135], v[144:147], v[84:87]
    ds_read_b64_tr_b16 v[186:187], v5 offset:21312
    v_mfma_f32_16x16x32_bf16 v[108:111], v[132:135], v[148:151], v[108:111]
    ds_read_b64_tr_b16 v[188:189], v5 offset:20832
    v_mfma_f32_16x16x32_bf16 v[104:107], v[128:131], v[148:151], v[104:107]
    ds_read_b64_tr_b16 v[190:191], v5 offset:21344
    v_mfma_f32_16x16x32_bf16 v[100:103], v[124:127], v[148:151], v[100:103]
    v_mfma_f32_16x16x32_bf16 v[96:99], v[120:123], v[148:151], v[96:99]
    v_mfma_f32_16x16x32_bf16 v[92:95], v[116:119], v[148:151], v[92:95]
    v_mfma_f32_16x16x32_bf16 v[88:91], v[112:115], v[148:151], v[88:91]
    s_waitcnt lgkmcnt(11)
    v_mfma_f32_16x16x32_bf16 v[16:19], v[152:155], v[176:179], v[16:19]
    s_waitcnt lgkmcnt(10)
    v_mfma_f32_16x16x32_bf16 v[20:23], v[156:159], v[176:179], v[20:23]
    s_waitcnt lgkmcnt(9)
    v_mfma_f32_16x16x32_bf16 v[24:27], v[160:163], v[176:179], v[24:27]
    s_waitcnt lgkmcnt(8)
    v_mfma_f32_16x16x32_bf16 v[28:31], v[164:167], v[176:179], v[28:31]
    s_waitcnt lgkmcnt(7)
    v_mfma_f32_16x16x32_bf16 v[32:35], v[168:171], v[176:179], v[32:35]
    s_waitcnt lgkmcnt(6)
    v_mfma_f32_16x16x32_bf16 v[36:39], v[172:175], v[176:179], v[36:39]
    s_waitcnt lgkmcnt(0)
    v_mfma_f32_16x16x32_bf16 v[60:63], v[172:175], v[180:183], v[60:63]
    s_barrier
    ds_read_b64_tr_b16 v[136:137], v4 offset:0
    v_mfma_f32_16x16x32_bf16 v[56:59], v[168:171], v[180:183], v[56:59]
    ds_read_b64_tr_b16 v[138:139], v4 offset:512
    v_mfma_f32_16x16x32_bf16 v[52:55], v[164:167], v[180:183], v[52:55]
    ds_read_b128 v[112:115], v6 offset:0
    v_mfma_f32_16x16x32_bf16 v[48:51], v[160:163], v[180:183], v[48:51]
    ds_read_b128 v[116:119], v6 offset:1024
    v_mfma_f32_16x16x32_bf16 v[44:47], v[156:159], v[180:183], v[44:47]
    ds_read_b128 v[120:123], v6 offset:2048
    v_mfma_f32_16x16x32_bf16 v[40:43], v[152:155], v[180:183], v[40:43]
    ds_read_b128 v[124:127], v6 offset:6144
    v_mfma_f32_16x16x32_bf16 v[64:67], v[152:155], v[184:187], v[64:67]
    ds_read_b128 v[128:131], v6 offset:7168
    v_mfma_f32_16x16x32_bf16 v[68:71], v[156:159], v[184:187], v[68:71]
    ds_read_b128 v[132:135], v6 offset:8192
    v_mfma_f32_16x16x32_bf16 v[72:75], v[160:163], v[184:187], v[72:75]
    ds_read_b64_tr_b16 v[140:141], v4 offset:32
    v_mfma_f32_16x16x32_bf16 v[76:79], v[164:167], v[184:187], v[76:79]
    ds_read_b64_tr_b16 v[142:143], v4 offset:544
    v_mfma_f32_16x16x32_bf16 v[80:83], v[168:171], v[184:187], v[80:83]
    ds_read_b64_tr_b16 v[144:145], v4 offset:64
    v_mfma_f32_16x16x32_bf16 v[84:87], v[172:175], v[184:187], v[84:87]
    ds_read_b64_tr_b16 v[146:147], v4 offset:576
    v_mfma_f32_16x16x32_bf16 v[108:111], v[172:175], v[188:191], v[108:111]
    ds_read_b64_tr_b16 v[148:149], v4 offset:96
    v_mfma_f32_16x16x32_bf16 v[104:107], v[168:171], v[188:191], v[104:107]
    ds_read_b64_tr_b16 v[150:151], v4 offset:608
    v_mfma_f32_16x16x32_bf16 v[100:103], v[164:167], v[188:191], v[100:103]
    v_mfma_f32_16x16x32_bf16 v[96:99], v[160:163], v[188:191], v[96:99]
    v_mfma_f32_16x16x32_bf16 v[92:95], v[156:159], v[188:191], v[92:95]
    v_mfma_f32_16x16x32_bf16 v[88:91], v[152:155], v[188:191], v[88:91]
    s_waitcnt lgkmcnt(11)
    v_mfma_f32_16x16x32_bf16 v[16:19], v[112:115], v[136:139], v[16:19]
    s_waitcnt lgkmcnt(10)
    v_mfma_f32_16x16x32_bf16 v[20:23], v[116:119], v[136:139], v[20:23]
    s_waitcnt lgkmcnt(9)
    v_mfma_f32_16x16x32_bf16 v[24:27], v[120:123], v[136:139], v[24:27]
    s_waitcnt lgkmcnt(8)
    v_mfma_f32_16x16x32_bf16 v[28:31], v[124:127], v[136:139], v[28:31]
    s_waitcnt lgkmcnt(7)
    v_mfma_f32_16x16x32_bf16 v[32:35], v[128:131], v[136:139], v[32:35]
    s_waitcnt lgkmcnt(6)
    v_mfma_f32_16x16x32_bf16 v[36:39], v[132:135], v[136:139], v[36:39]
    s_waitcnt lgkmcnt(0)
    v_mfma_f32_16x16x32_bf16 v[60:63], v[132:135], v[140:143], v[60:63]
    s_barrier
    ds_read_b64_tr_b16 v[176:177], v4 offset:20736
    v_mfma_f32_16x16x32_bf16 v[56:59], v[128:131], v[140:143], v[56:59]
    ds_read_b64_tr_b16 v[178:179], v4 offset:21248
    v_mfma_f32_16x16x32_bf16 v[52:55], v[124:127], v[140:143], v[52:55]
    ds_read_b128 v[152:155], v6 offset:20736
    v_mfma_f32_16x16x32_bf16 v[48:51], v[120:123], v[140:143], v[48:51]
    ds_read_b128 v[156:159], v6 offset:21760
    v_mfma_f32_16x16x32_bf16 v[44:47], v[116:119], v[140:143], v[44:47]
    ds_read_b128 v[160:163], v6 offset:22784
    v_mfma_f32_16x16x32_bf16 v[40:43], v[112:115], v[140:143], v[40:43]
    ds_read_b128 v[164:167], v6 offset:26880
    v_mfma_f32_16x16x32_bf16 v[64:67], v[112:115], v[144:147], v[64:67]
    ds_read_b128 v[168:171], v6 offset:27904
    v_mfma_f32_16x16x32_bf16 v[68:71], v[116:119], v[144:147], v[68:71]
    ds_read_b128 v[172:175], v6 offset:28928
    v_mfma_f32_16x16x32_bf16 v[72:75], v[120:123], v[144:147], v[72:75]
    ds_read_b64_tr_b16 v[180:181], v4 offset:20768
    v_mfma_f32_16x16x32_bf16 v[76:79], v[124:127], v[144:147], v[76:79]
    ds_read_b64_tr_b16 v[182:183], v4 offset:21280
    v_mfma_f32_16x16x32_bf16 v[80:83], v[128:131], v[144:147], v[80:83]
    ds_read_b64_tr_b16 v[184:185], v4 offset:20800
    v_mfma_f32_16x16x32_bf16 v[84:87], v[132:135], v[144:147], v[84:87]
    ds_read_b64_tr_b16 v[186:187], v4 offset:21312
    v_mfma_f32_16x16x32_bf16 v[108:111], v[132:135], v[148:151], v[108:111]
    ds_read_b64_tr_b16 v[188:189], v4 offset:20832
    v_mfma_f32_16x16x32_bf16 v[104:107], v[128:131], v[148:151], v[104:107]
    ds_read_b64_tr_b16 v[190:191], v4 offset:21344
    v_mfma_f32_16x16x32_bf16 v[100:103], v[124:127], v[148:151], v[100:103]
    v_mfma_f32_16x16x32_bf16 v[96:99], v[120:123], v[148:151], v[96:99]
    v_mfma_f32_16x16x32_bf16 v[92:95], v[116:119], v[148:151], v[92:95]
    v_mfma_f32_16x16x32_bf16 v[88:91], v[112:115], v[148:151], v[88:91]
    s_waitcnt lgkmcnt(11)
    v_mfma_f32_16x16x32_bf16 v[16:19], v[152:155], v[176:179], v[16:19]
    s_waitcnt lgkmcnt(10)
    v_mfma_f32_16x16x32_bf16 v[20:23], v[156:159], v[176:179], v[20:23]
    s_waitcnt lgkmcnt(9)
    v_mfma_f32_16x16x32_bf16 v[24:27], v[160:163], v[176:179], v[24:27]
    s_waitcnt lgkmcnt(8)
    v_mfma_f32_16x16x32_bf16 v[28:31], v[164:167], v[176:179], v[28:31]
    s_waitcnt lgkmcnt(7)
    v_mfma_f32_16x16x32_bf16 v[32:35], v[168:171], v[176:179], v[32:35]
    s_waitcnt lgkmcnt(6)
    v_mfma_f32_16x16x32_bf16 v[36:39], v[172:175], v[176:179], v[36:39]
    s_waitcnt lgkmcnt(0)
    v_mfma_f32_16x16x32_bf16 v[60:63], v[172:175], v[180:183], v[60:63]
    s_barrier
    ds_read_b64_tr_b16 v[136:137], v5 offset:0
    v_mfma_f32_16x16x32_bf16 v[56:59], v[168:171], v[180:183], v[56:59]
    ds_read_b64_tr_b16 v[138:139], v5 offset:512
    v_mfma_f32_16x16x32_bf16 v[52:55], v[164:167], v[180:183], v[52:55]
    ds_read_b128 v[112:115], v7 offset:0
    v_mfma_f32_16x16x32_bf16 v[48:51], v[160:163], v[180:183], v[48:51]
    ds_read_b128 v[116:119], v7 offset:1024
    v_mfma_f32_16x16x32_bf16 v[44:47], v[156:159], v[180:183], v[44:47]
    ds_read_b128 v[120:123], v7 offset:2048
    v_mfma_f32_16x16x32_bf16 v[40:43], v[152:155], v[180:183], v[40:43]
    ds_read_b128 v[124:127], v7 offset:6144
    v_mfma_f32_16x16x32_bf16 v[64:67], v[152:155], v[184:187], v[64:67]
    ds_read_b128 v[128:131], v7 offset:7168
    v_mfma_f32_16x16x32_bf16 v[68:71], v[156:159], v[184:187], v[68:71]
    ds_read_b128 v[132:135], v7 offset:8192
    v_mfma_f32_16x16x32_bf16 v[72:75], v[160:163], v[184:187], v[72:75]
    ds_read_b64_tr_b16 v[140:141], v5 offset:32
    v_mfma_f32_16x16x32_bf16 v[76:79], v[164:167], v[184:187], v[76:79]
    ds_read_b64_tr_b16 v[142:143], v5 offset:544
    v_mfma_f32_16x16x32_bf16 v[80:83], v[168:171], v[184:187], v[80:83]
    ds_read_b64_tr_b16 v[144:145], v5 offset:64
    v_mfma_f32_16x16x32_bf16 v[84:87], v[172:175], v[184:187], v[84:87]
    ds_read_b64_tr_b16 v[146:147], v5 offset:576
    v_mfma_f32_16x16x32_bf16 v[108:111], v[172:175], v[188:191], v[108:111]
    ds_read_b64_tr_b16 v[148:149], v5 offset:96
    v_mfma_f32_16x16x32_bf16 v[104:107], v[168:171], v[188:191], v[104:107]
    ds_read_b64_tr_b16 v[150:151], v5 offset:608
    v_mfma_f32_16x16x32_bf16 v[100:103], v[164:167], v[188:191], v[100:103]
    v_mfma_f32_16x16x32_bf16 v[96:99], v[160:163], v[188:191], v[96:99]
    v_mfma_f32_16x16x32_bf16 v[92:95], v[156:159], v[188:191], v[92:95]
    v_mfma_f32_16x16x32_bf16 v[88:91], v[152:155], v[188:191], v[88:91]
    s_waitcnt lgkmcnt(11)
    v_mfma_f32_16x16x32_bf16 v[16:19], v[112:115], v[136:139], v[16:19]
    s_waitcnt lgkmcnt(10)
    v_mfma_f32_16x16x32_bf16 v[20:23], v[116:119], v[136:139], v[20:23]
    s_waitcnt lgkmcnt(9)
    v_mfma_f32_16x16x32_bf16 v[24:27], v[120:123], v[136:139], v[24:27]
    s_waitcnt lgkmcnt(8)
    v_mfma_f32_16x16x32_bf16 v[28:31], v[124:127], v[136:139], v[28:31]
    s_waitcnt lgkmcnt(7)
    v_mfma_f32_16x16x32_bf16 v[32:35], v[128:131], v[136:139], v[32:35]
    s_waitcnt lgkmcnt(6)
    v_mfma_f32_16x16x32_bf16 v[36:39], v[132:135], v[136:139], v[36:39]
    s_waitcnt lgkmcnt(0)
    v_mfma_f32_16x16x32_bf16 v[60:63], v[132:135], v[140:143], v[60:63]
    s_barrier
    ds_read_b64_tr_b16 v[176:177], v5 offset:20736
    v_mfma_f32_16x16x32_bf16 v[56:59], v[128:131], v[140:143], v[56:59]
    ds_read_b64_tr_b16 v[178:179], v5 offset:21248
    v_mfma_f32_16x16x32_bf16 v[52:55], v[124:127], v[140:143], v[52:55]
    ds_read_b128 v[152:155], v7 offset:20736
    v_mfma_f32_16x16x32_bf16 v[48:51], v[120:123], v[140:143], v[48:51]
    ds_read_b128 v[156:159], v7 offset:21760
    v_mfma_f32_16x16x32_bf16 v[44:47], v[116:119], v[140:143], v[44:47]
    ds_read_b128 v[160:163], v7 offset:22784
    v_mfma_f32_16x16x32_bf16 v[40:43], v[112:115], v[140:143], v[40:43]
    ds_read_b128 v[164:167], v7 offset:26880
    v_mfma_f32_16x16x32_bf16 v[64:67], v[112:115], v[144:147], v[64:67]
    ds_read_b128 v[168:171], v7 offset:27904
    v_mfma_f32_16x16x32_bf16 v[68:71], v[116:119], v[144:147], v[68:71]
    ds_read_b128 v[172:175], v7 offset:28928
    v_mfma_f32_16x16x32_bf16 v[72:75], v[120:123], v[144:147], v[72:75]
    ds_read_b64_tr_b16 v[180:181], v5 offset:20768
    v_mfma_f32_16x16x32_bf16 v[76:79], v[124:127], v[144:147], v[76:79]
    ds_read_b64_tr_b16 v[182:183], v5 offset:21280
    v_mfma_f32_16x16x32_bf16 v[80:83], v[128:131], v[144:147], v[80:83]
    ds_read_b64_tr_b16 v[184:185], v5 offset:20800
    v_mfma_f32_16x16x32_bf16 v[84:87], v[132:135], v[144:147], v[84:87]
    ds_read_b64_tr_b16 v[186:187], v5 offset:21312
    v_mfma_f32_16x16x32_bf16 v[108:111], v[132:135], v[148:151], v[108:111]
    ds_read_b64_tr_b16 v[188:189], v5 offset:20832
    v_mfma_f32_16x16x32_bf16 v[104:107], v[128:131], v[148:151], v[104:107]
    ds_read_b64_tr_b16 v[190:191], v5 offset:21344
    v_mfma_f32_16x16x32_bf16 v[100:103], v[124:127], v[148:151], v[100:103]
    v_mfma_f32_16x16x32_bf16 v[96:99], v[120:123], v[148:151], v[96:99]
    v_mfma_f32_16x16x32_bf16 v[92:95], v[116:119], v[148:151], v[92:95]
    v_mfma_f32_16x16x32_bf16 v[88:91], v[112:115], v[148:151], v[88:91]
    s_waitcnt lgkmcnt(11)
    v_mfma_f32_16x16x32_bf16 v[16:19], v[152:155], v[176:179], v[16:19]
    s_waitcnt lgkmcnt(10)
    v_mfma_f32_16x16x32_bf16 v[20:23], v[156:159], v[176:179], v[20:23]
    s_waitcnt lgkmcnt(9)
    v_mfma_f32_16x16x32_bf16 v[24:27], v[160:163], v[176:179], v[24:27]
    s_waitcnt lgkmcnt(8)
    v_mfma_f32_16x16x32_bf16 v[28:31], v[164:167], v[176:179], v[28:31]
    s_waitcnt lgkmcnt(7)
    v_mfma_f32_16x16x32_bf16 v[32:35], v[168:171], v[176:179], v[32:35]
    s_waitcnt lgkmcnt(6)
    v_mfma_f32_16x16x32_bf16 v[36:39], v[172:175], v[176:179], v[36:39]
    s_waitcnt lgkmcnt(0)
    v_mfma_f32_16x16x32_bf16 v[60:63], v[172:175], v[180:183], v[60:63]
    s_barrier
    ds_read_b64_tr_b16 v[136:137], v4 offset:0
    v_mfma_f32_16x16x32_bf16 v[56:59], v[168:171], v[180:183], v[56:59]
    ds_read_b64_tr_b16 v[138:139], v4 offset:512
    v_mfma_f32_16x16x32_bf16 v[52:55], v[164:167], v[180:183], v[52:55]
    ds_read_b128 v[112:115], v6 offset:0
    v_mfma_f32_16x16x32_bf16 v[48:51], v[160:163], v[180:183], v[48:51]
    ds_read_b128 v[116:119], v6 offset:1024
    v_mfma_f32_16x16x32_bf16 v[44:47], v[156:159], v[180:183], v[44:47]
    ds_read_b128 v[120:123], v6 offset:2048
    v_mfma_f32_16x16x32_bf16 v[40:43], v[152:155], v[180:183], v[40:43]
    ds_read_b128 v[124:127], v6 offset:6144
    v_mfma_f32_16x16x32_bf16 v[64:67], v[152:155], v[184:187], v[64:67]
    ds_read_b128 v[128:131], v6 offset:7168
    v_mfma_f32_16x16x32_bf16 v[68:71], v[156:159], v[184:187], v[68:71]
    ds_read_b128 v[132:135], v6 offset:8192
    v_mfma_f32_16x16x32_bf16 v[72:75], v[160:163], v[184:187], v[72:75]
    ds_read_b64_tr_b16 v[140:141], v4 offset:32
    v_mfma_f32_16x16x32_bf16 v[76:79], v[164:167], v[184:187], v[76:79]
    ds_read_b64_tr_b16 v[142:143], v4 offset:544
    v_mfma_f32_16x16x32_bf16 v[80:83], v[168:171], v[184:187], v[80:83]
    ds_read_b64_tr_b16 v[144:145], v4 offset:64
    v_mfma_f32_16x16x32_bf16 v[84:87], v[172:175], v[184:187], v[84:87]
    ds_read_b64_tr_b16 v[146:147], v4 offset:576
    v_mfma_f32_16x16x32_bf16 v[108:111], v[172:175], v[188:191], v[108:111]
    ds_read_b64_tr_b16 v[148:149], v4 offset:96
    v_mfma_f32_16x16x32_bf16 v[104:107], v[168:171], v[188:191], v[104:107]
    ds_read_b64_tr_b16 v[150:151], v4 offset:608
    v_mfma_f32_16x16x32_bf16 v[100:103], v[164:167], v[188:191], v[100:103]
    v_mfma_f32_16x16x32_bf16 v[96:99], v[160:163], v[188:191], v[96:99]
    v_mfma_f32_16x16x32_bf16 v[92:95], v[156:159], v[188:191], v[92:95]
    v_mfma_f32_16x16x32_bf16 v[88:91], v[152:155], v[188:191], v[88:91]
    s_waitcnt lgkmcnt(11)
    v_mfma_f32_16x16x32_bf16 v[16:19], v[112:115], v[136:139], v[16:19]
    s_waitcnt lgkmcnt(10)
    v_mfma_f32_16x16x32_bf16 v[20:23], v[116:119], v[136:139], v[20:23]
    s_waitcnt lgkmcnt(9)
    v_mfma_f32_16x16x32_bf16 v[24:27], v[120:123], v[136:139], v[24:27]
    s_waitcnt lgkmcnt(8)
    v_mfma_f32_16x16x32_bf16 v[28:31], v[124:127], v[136:139], v[28:31]
    s_waitcnt lgkmcnt(7)
    v_mfma_f32_16x16x32_bf16 v[32:35], v[128:131], v[136:139], v[32:35]
    s_waitcnt lgkmcnt(6)
    v_mfma_f32_16x16x32_bf16 v[36:39], v[132:135], v[136:139], v[36:39]
    s_waitcnt lgkmcnt(0)
    v_mfma_f32_16x16x32_bf16 v[60:63], v[132:135], v[140:143], v[60:63]
    s_barrier
    ds_read_b64_tr_b16 v[176:177], v4 offset:20736
    v_mfma_f32_16x16x32_bf16 v[56:59], v[128:131], v[140:143], v[56:59]
    ds_read_b64_tr_b16 v[178:179], v4 offset:21248
    v_mfma_f32_16x16x32_bf16 v[52:55], v[124:127], v[140:143], v[52:55]
    ds_read_b128 v[152:155], v6 offset:20736
    v_mfma_f32_16x16x32_bf16 v[48:51], v[120:123], v[140:143], v[48:51]
    ds_read_b128 v[156:159], v6 offset:21760
    v_mfma_f32_16x16x32_bf16 v[44:47], v[116:119], v[140:143], v[44:47]
    ds_read_b128 v[160:163], v6 offset:22784
    v_mfma_f32_16x16x32_bf16 v[40:43], v[112:115], v[140:143], v[40:43]
    ds_read_b128 v[164:167], v6 offset:26880
    v_mfma_f32_16x16x32_bf16 v[64:67], v[112:115], v[144:147], v[64:67]
    ds_read_b128 v[168:171], v6 offset:27904
    v_mfma_f32_16x16x32_bf16 v[68:71], v[116:119], v[144:147], v[68:71]
    ds_read_b128 v[172:175], v6 offset:28928
    v_mfma_f32_16x16x32_bf16 v[72:75], v[120:123], v[144:147], v[72:75]
    ds_read_b64_tr_b16 v[180:181], v4 offset:20768
    v_mfma_f32_16x16x32_bf16 v[76:79], v[124:127], v[144:147], v[76:79]
    ds_read_b64_tr_b16 v[182:183], v4 offset:21280
    v_mfma_f32_16x16x32_bf16 v[80:83], v[128:131], v[144:147], v[80:83]
    ds_read_b64_tr_b16 v[184:185], v4 offset:20800
    v_mfma_f32_16x16x32_bf16 v[84:87], v[132:135], v[144:147], v[84:87]
    ds_read_b64_tr_b16 v[186:187], v4 offset:21312
    v_mfma_f32_16x16x32_bf16 v[108:111], v[132:135], v[148:151], v[108:111]
    ds_read_b64_tr_b16 v[188:189], v4 offset:20832
    v_mfma_f32_16x16x32_bf16 v[104:107], v[128:131], v[148:151], v[104:107]
    ds_read_b64_tr_b16 v[190:191], v4 offset:21344
    v_mfma_f32_16x16x32_bf16 v[100:103], v[124:127], v[148:151], v[100:103]
    v_mfma_f32_16x16x32_bf16 v[96:99], v[120:123], v[148:151], v[96:99]
    v_mfma_f32_16x16x32_bf16 v[92:95], v[116:119], v[148:151], v[92:95]
    v_mfma_f32_16x16x32_bf16 v[88:91], v[112:115], v[148:151], v[88:91]
    s_waitcnt lgkmcnt(11)
    v_mfma_f32_16x16x32_bf16 v[16:19], v[152:155], v[176:179], v[16:19]
    s_waitcnt lgkmcnt(10)
    v_mfma_f32_16x16x32_bf16 v[20:23], v[156:159], v[176:179], v[20:23]
    s_waitcnt lgkmcnt(9)
    v_mfma_f32_16x16x32_bf16 v[24:27], v[160:163], v[176:179], v[24:27]
    s_waitcnt lgkmcnt(8)
    v_mfma_f32_16x16x32_bf16 v[28:31], v[164:167], v[176:179], v[28:31]
    s_waitcnt lgkmcnt(7)
    v_mfma_f32_16x16x32_bf16 v[32:35], v[168:171], v[176:179], v[32:35]
    s_waitcnt lgkmcnt(6)
    v_mfma_f32_16x16x32_bf16 v[36:39], v[172:175], v[176:179], v[36:39]
    s_waitcnt lgkmcnt(0)
    v_mfma_f32_16x16x32_bf16 v[60:63], v[172:175], v[180:183], v[60:63]
    s_barrier
    ds_read_b64_tr_b16 v[136:137], v5 offset:0
    v_mfma_f32_16x16x32_bf16 v[56:59], v[168:171], v[180:183], v[56:59]
    ds_read_b64_tr_b16 v[138:139], v5 offset:512
    v_mfma_f32_16x16x32_bf16 v[52:55], v[164:167], v[180:183], v[52:55]
    ds_read_b128 v[112:115], v7 offset:0
    v_mfma_f32_16x16x32_bf16 v[48:51], v[160:163], v[180:183], v[48:51]
    ds_read_b128 v[116:119], v7 offset:1024
    v_mfma_f32_16x16x32_bf16 v[44:47], v[156:159], v[180:183], v[44:47]
    ds_read_b128 v[120:123], v7 offset:2048
    v_mfma_f32_16x16x32_bf16 v[40:43], v[152:155], v[180:183], v[40:43]
    ds_read_b128 v[124:127], v7 offset:6144
    v_mfma_f32_16x16x32_bf16 v[64:67], v[152:155], v[184:187], v[64:67]
    ds_read_b128 v[128:131], v7 offset:7168
    v_mfma_f32_16x16x32_bf16 v[68:71], v[156:159], v[184:187], v[68:71]
    ds_read_b128 v[132:135], v7 offset:8192
    v_mfma_f32_16x16x32_bf16 v[72:75], v[160:163], v[184:187], v[72:75]
    ds_read_b64_tr_b16 v[140:141], v5 offset:32
    v_mfma_f32_16x16x32_bf16 v[76:79], v[164:167], v[184:187], v[76:79]
    ds_read_b64_tr_b16 v[142:143], v5 offset:544
    v_mfma_f32_16x16x32_bf16 v[80:83], v[168:171], v[184:187], v[80:83]
    ds_read_b64_tr_b16 v[144:145], v5 offset:64
    v_mfma_f32_16x16x32_bf16 v[84:87], v[172:175], v[184:187], v[84:87]
    ds_read_b64_tr_b16 v[146:147], v5 offset:576
    v_mfma_f32_16x16x32_bf16 v[108:111], v[172:175], v[188:191], v[108:111]
    ds_read_b64_tr_b16 v[148:149], v5 offset:96
    v_mfma_f32_16x16x32_bf16 v[104:107], v[168:171], v[188:191], v[104:107]
    ds_read_b64_tr_b16 v[150:151], v5 offset:608
    v_mfma_f32_16x16x32_bf16 v[100:103], v[164:167], v[188:191], v[100:103]
    v_mfma_f32_16x16x32_bf16 v[96:99], v[160:163], v[188:191], v[96:99]
    v_mfma_f32_16x16x32_bf16 v[92:95], v[156:159], v[188:191], v[92:95]
    v_mfma_f32_16x16x32_bf16 v[88:91], v[152:155], v[188:191], v[88:91]
    s_waitcnt lgkmcnt(11)
    v_mfma_f32_16x16x32_bf16 v[16:19], v[112:115], v[136:139], v[16:19]
    s_waitcnt lgkmcnt(10)
    v_mfma_f32_16x16x32_bf16 v[20:23], v[116:119], v[136:139], v[20:23]
    s_waitcnt lgkmcnt(9)
    v_mfma_f32_16x16x32_bf16 v[24:27], v[120:123], v[136:139], v[24:27]
    s_waitcnt lgkmcnt(8)
    v_mfma_f32_16x16x32_bf16 v[28:31], v[124:127], v[136:139], v[28:31]
    s_waitcnt lgkmcnt(7)
    v_mfma_f32_16x16x32_bf16 v[32:35], v[128:131], v[136:139], v[32:35]
    s_waitcnt lgkmcnt(6)
    v_mfma_f32_16x16x32_bf16 v[36:39], v[132:135], v[136:139], v[36:39]
    s_waitcnt lgkmcnt(0)
    v_mfma_f32_16x16x32_bf16 v[60:63], v[132:135], v[140:143], v[60:63]
    s_barrier
    ds_read_b64_tr_b16 v[176:177], v5 offset:20736
    v_mfma_f32_16x16x32_bf16 v[56:59], v[128:131], v[140:143], v[56:59]
    ds_read_b64_tr_b16 v[178:179], v5 offset:21248
    v_mfma_f32_16x16x32_bf16 v[52:55], v[124:127], v[140:143], v[52:55]
    ds_read_b128 v[152:155], v7 offset:20736
    v_mfma_f32_16x16x32_bf16 v[48:51], v[120:123], v[140:143], v[48:51]
    ds_read_b128 v[156:159], v7 offset:21760
    v_mfma_f32_16x16x32_bf16 v[44:47], v[116:119], v[140:143], v[44:47]
    ds_read_b128 v[160:163], v7 offset:22784
    v_mfma_f32_16x16x32_bf16 v[40:43], v[112:115], v[140:143], v[40:43]
    ds_read_b128 v[164:167], v7 offset:26880
    v_mfma_f32_16x16x32_bf16 v[64:67], v[112:115], v[144:147], v[64:67]
    ds_read_b128 v[168:171], v7 offset:27904
    v_mfma_f32_16x16x32_bf16 v[68:71], v[116:119], v[144:147], v[68:71]
    ds_read_b128 v[172:175], v7 offset:28928
    v_mfma_f32_16x16x32_bf16 v[72:75], v[120:123], v[144:147], v[72:75]
    ds_read_b64_tr_b16 v[180:181], v5 offset:20768
    v_mfma_f32_16x16x32_bf16 v[76:79], v[124:127], v[144:147], v[76:79]
    ds_read_b64_tr_b16 v[182:183], v5 offset:21280
    v_mfma_f32_16x16x32_bf16 v[80:83], v[128:131], v[144:147], v[80:83]
    ds_read_b64_tr_b16 v[184:185], v5 offset:20800
    v_mfma_f32_16x16x32_bf16 v[84:87], v[132:135], v[144:147], v[84:87]
    ds_read_b64_tr_b16 v[186:187], v5 offset:21312
    v_mfma_f32_16x16x32_bf16 v[108:111], v[132:135], v[148:151], v[108:111]
    ds_read_b64_tr_b16 v[188:189], v5 offset:20832
    v_mfma_f32_16x16x32_bf16 v[104:107], v[128:131], v[148:151], v[104:107]
    ds_read_b64_tr_b16 v[190:191], v5 offset:21344
    v_mfma_f32_16x16x32_bf16 v[100:103], v[124:127], v[148:151], v[100:103]
    v_mfma_f32_16x16x32_bf16 v[96:99], v[120:123], v[148:151], v[96:99]
    v_mfma_f32_16x16x32_bf16 v[92:95], v[116:119], v[148:151], v[92:95]
    v_mfma_f32_16x16x32_bf16 v[88:91], v[112:115], v[148:151], v[88:91]
    s_waitcnt lgkmcnt(11)
    v_mfma_f32_16x16x32_bf16 v[16:19], v[152:155], v[176:179], v[16:19]
    s_waitcnt lgkmcnt(10)
    v_mfma_f32_16x16x32_bf16 v[20:23], v[156:159], v[176:179], v[20:23]
    s_waitcnt lgkmcnt(9)
    v_mfma_f32_16x16x32_bf16 v[24:27], v[160:163], v[176:179], v[24:27]
    s_waitcnt lgkmcnt(8)
    v_mfma_f32_16x16x32_bf16 v[28:31], v[164:167], v[176:179], v[28:31]
    s_waitcnt lgkmcnt(7)
    v_mfma_f32_16x16x32_bf16 v[32:35], v[168:171], v[176:179], v[32:35]
    s_waitcnt lgkmcnt(6)
    v_mfma_f32_16x16x32_bf16 v[36:39], v[172:175], v[176:179], v[36:39]
    s_waitcnt lgkmcnt(0)
    v_mfma_f32_16x16x32_bf16 v[60:63], v[172:175], v[180:183], v[60:63]
    s_barrier
    ds_read_b64_tr_b16 v[136:137], v4 offset:0
    v_mfma_f32_16x16x32_bf16 v[56:59], v[168:171], v[180:183], v[56:59]
    ds_read_b64_tr_b16 v[138:139], v4 offset:512
    v_mfma_f32_16x16x32_bf16 v[52:55], v[164:167], v[180:183], v[52:55]
    ds_read_b128 v[112:115], v6 offset:0
    v_mfma_f32_16x16x32_bf16 v[48:51], v[160:163], v[180:183], v[48:51]
    ds_read_b128 v[116:119], v6 offset:1024
    v_mfma_f32_16x16x32_bf16 v[44:47], v[156:159], v[180:183], v[44:47]
    ds_read_b128 v[120:123], v6 offset:2048
    v_mfma_f32_16x16x32_bf16 v[40:43], v[152:155], v[180:183], v[40:43]
    ds_read_b128 v[124:127], v6 offset:6144
    v_mfma_f32_16x16x32_bf16 v[64:67], v[152:155], v[184:187], v[64:67]
    ds_read_b128 v[128:131], v6 offset:7168
    v_mfma_f32_16x16x32_bf16 v[68:71], v[156:159], v[184:187], v[68:71]
    ds_read_b128 v[132:135], v6 offset:8192
    v_mfma_f32_16x16x32_bf16 v[72:75], v[160:163], v[184:187], v[72:75]
    ds_read_b64_tr_b16 v[140:141], v4 offset:32
    v_mfma_f32_16x16x32_bf16 v[76:79], v[164:167], v[184:187], v[76:79]
    ds_read_b64_tr_b16 v[142:143], v4 offset:544
    v_mfma_f32_16x16x32_bf16 v[80:83], v[168:171], v[184:187], v[80:83]
    ds_read_b64_tr_b16 v[144:145], v4 offset:64
    v_mfma_f32_16x16x32_bf16 v[84:87], v[172:175], v[184:187], v[84:87]
    ds_read_b64_tr_b16 v[146:147], v4 offset:576
    v_mfma_f32_16x16x32_bf16 v[108:111], v[172:175], v[188:191], v[108:111]
    ds_read_b64_tr_b16 v[148:149], v4 offset:96
    v_mfma_f32_16x16x32_bf16 v[104:107], v[168:171], v[188:191], v[104:107]
    ds_read_b64_tr_b16 v[150:151], v4 offset:608
    v_mfma_f32_16x16x32_bf16 v[100:103], v[164:167], v[188:191], v[100:103]
    v_mfma_f32_16x16x32_bf16 v[96:99], v[160:163], v[188:191], v[96:99]
    v_mfma_f32_16x16x32_bf16 v[92:95], v[156:159], v[188:191], v[92:95]
    v_mfma_f32_16x16x32_bf16 v[88:91], v[152:155], v[188:191], v[88:91]
    s_waitcnt lgkmcnt(11)
    v_mfma_f32_16x16x32_bf16 v[16:19], v[112:115], v[136:139], v[16:19]
    s_waitcnt lgkmcnt(10)
    v_mfma_f32_16x16x32_bf16 v[20:23], v[116:119], v[136:139], v[20:23]
    s_waitcnt lgkmcnt(9)
    v_mfma_f32_16x16x32_bf16 v[24:27], v[120:123], v[136:139], v[24:27]
    s_waitcnt lgkmcnt(8)
    v_mfma_f32_16x16x32_bf16 v[28:31], v[124:127], v[136:139], v[28:31]
    s_waitcnt lgkmcnt(7)
    v_mfma_f32_16x16x32_bf16 v[32:35], v[128:131], v[136:139], v[32:35]
    s_waitcnt lgkmcnt(6)
    v_mfma_f32_16x16x32_bf16 v[36:39], v[132:135], v[136:139], v[36:39]
    s_waitcnt lgkmcnt(0)
    v_mfma_f32_16x16x32_bf16 v[60:63], v[132:135], v[140:143], v[60:63]
    s_barrier
    ds_read_b64_tr_b16 v[176:177], v4 offset:20736
    v_mfma_f32_16x16x32_bf16 v[56:59], v[128:131], v[140:143], v[56:59]
    ds_read_b64_tr_b16 v[178:179], v4 offset:21248
    v_mfma_f32_16x16x32_bf16 v[52:55], v[124:127], v[140:143], v[52:55]
    ds_read_b128 v[152:155], v6 offset:20736
    v_mfma_f32_16x16x32_bf16 v[48:51], v[120:123], v[140:143], v[48:51]
    ds_read_b128 v[156:159], v6 offset:21760
    v_mfma_f32_16x16x32_bf16 v[44:47], v[116:119], v[140:143], v[44:47]
    ds_read_b128 v[160:163], v6 offset:22784
    v_mfma_f32_16x16x32_bf16 v[40:43], v[112:115], v[140:143], v[40:43]
    ds_read_b128 v[164:167], v6 offset:26880
    v_mfma_f32_16x16x32_bf16 v[64:67], v[112:115], v[144:147], v[64:67]
    ds_read_b128 v[168:171], v6 offset:27904
    v_mfma_f32_16x16x32_bf16 v[68:71], v[116:119], v[144:147], v[68:71]
    ds_read_b128 v[172:175], v6 offset:28928
    v_mfma_f32_16x16x32_bf16 v[72:75], v[120:123], v[144:147], v[72:75]
    ds_read_b64_tr_b16 v[180:181], v4 offset:20768
    v_mfma_f32_16x16x32_bf16 v[76:79], v[124:127], v[144:147], v[76:79]
    ds_read_b64_tr_b16 v[182:183], v4 offset:21280
    v_mfma_f32_16x16x32_bf16 v[80:83], v[128:131], v[144:147], v[80:83]
    ds_read_b64_tr_b16 v[184:185], v4 offset:20800
    v_mfma_f32_16x16x32_bf16 v[84:87], v[132:135], v[144:147], v[84:87]
    ds_read_b64_tr_b16 v[186:187], v4 offset:21312
    v_mfma_f32_16x16x32_bf16 v[108:111], v[132:135], v[148:151], v[108:111]
    ds_read_b64_tr_b16 v[188:189], v4 offset:20832
    v_mfma_f32_16x16x32_bf16 v[104:107], v[128:131], v[148:151], v[104:107]
    ds_read_b64_tr_b16 v[190:191], v4 offset:21344
    v_mfma_f32_16x16x32_bf16 v[100:103], v[124:127], v[148:151], v[100:103]
    v_mfma_f32_16x16x32_bf16 v[96:99], v[120:123], v[148:151], v[96:99]
    v_mfma_f32_16x16x32_bf16 v[92:95], v[116:119], v[148:151], v[92:95]
    v_mfma_f32_16x16x32_bf16 v[88:91], v[112:115], v[148:151], v[88:91]
    s_waitcnt lgkmcnt(11)
    v_mfma_f32_16x16x32_bf16 v[16:19], v[152:155], v[176:179], v[16:19]
    s_waitcnt lgkmcnt(10)
    v_mfma_f32_16x16x32_bf16 v[20:23], v[156:159], v[176:179], v[20:23]
    s_waitcnt lgkmcnt(9)
    v_mfma_f32_16x16x32_bf16 v[24:27], v[160:163], v[176:179], v[24:27]
    s_waitcnt lgkmcnt(8)
    v_mfma_f32_16x16x32_bf16 v[28:31], v[164:167], v[176:179], v[28:31]
    s_waitcnt lgkmcnt(7)
    v_mfma_f32_16x16x32_bf16 v[32:35], v[168:171], v[176:179], v[32:35]
    s_waitcnt lgkmcnt(6)
    v_mfma_f32_16x16x32_bf16 v[36:39], v[172:175], v[176:179], v[36:39]
    s_waitcnt lgkmcnt(0)
    v_mfma_f32_16x16x32_bf16 v[60:63], v[172:175], v[180:183], v[60:63]
    s_barrier
    ds_read_b64_tr_b16 v[136:137], v5 offset:0
    v_mfma_f32_16x16x32_bf16 v[56:59], v[168:171], v[180:183], v[56:59]
    ds_read_b64_tr_b16 v[138:139], v5 offset:512
    v_mfma_f32_16x16x32_bf16 v[52:55], v[164:167], v[180:183], v[52:55]
    ds_read_b128 v[112:115], v7 offset:0
    v_mfma_f32_16x16x32_bf16 v[48:51], v[160:163], v[180:183], v[48:51]
    ds_read_b128 v[116:119], v7 offset:1024
    v_mfma_f32_16x16x32_bf16 v[44:47], v[156:159], v[180:183], v[44:47]
    ds_read_b128 v[120:123], v7 offset:2048
    v_mfma_f32_16x16x32_bf16 v[40:43], v[152:155], v[180:183], v[40:43]
    ds_read_b128 v[124:127], v7 offset:6144
    v_mfma_f32_16x16x32_bf16 v[64:67], v[152:155], v[184:187], v[64:67]
    ds_read_b128 v[128:131], v7 offset:7168
    v_mfma_f32_16x16x32_bf16 v[68:71], v[156:159], v[184:187], v[68:71]
    ds_read_b128 v[132:135], v7 offset:8192
    v_mfma_f32_16x16x32_bf16 v[72:75], v[160:163], v[184:187], v[72:75]
    ds_read_b64_tr_b16 v[140:141], v5 offset:32
    v_mfma_f32_16x16x32_bf16 v[76:79], v[164:167], v[184:187], v[76:79]
    ds_read_b64_tr_b16 v[142:143], v5 offset:544
    v_mfma_f32_16x16x32_bf16 v[80:83], v[168:171], v[184:187], v[80:83]
    ds_read_b64_tr_b16 v[144:145], v5 offset:64
    v_mfma_f32_16x16x32_bf16 v[84:87], v[172:175], v[184:187], v[84:87]
    ds_read_b64_tr_b16 v[146:147], v5 offset:576
    v_mfma_f32_16x16x32_bf16 v[108:111], v[172:175], v[188:191], v[108:111]
    ds_read_b64_tr_b16 v[148:149], v5 offset:96
    v_mfma_f32_16x16x32_bf16 v[104:107], v[168:171], v[188:191], v[104:107]
    ds_read_b64_tr_b16 v[150:151], v5 offset:608
    v_mfma_f32_16x16x32_bf16 v[100:103], v[164:167], v[188:191], v[100:103]
    v_mfma_f32_16x16x32_bf16 v[96:99], v[160:163], v[188:191], v[96:99]
    v_mfma_f32_16x16x32_bf16 v[92:95], v[156:159], v[188:191], v[92:95]
    v_mfma_f32_16x16x32_bf16 v[88:91], v[152:155], v[188:191], v[88:91]
    s_waitcnt lgkmcnt(0)
    v_mfma_f32_16x16x32_bf16 v[16:19], v[112:115], v[136:139], v[16:19]
    s_barrier
    ds_read_b64_tr_b16 v[176:177], v5 offset:20736
    ds_read_b64_tr_b16 v[178:179], v5 offset:21248
    v_mfma_f32_16x16x32_bf16 v[20:23], v[116:119], v[136:139], v[20:23]
    ds_read_b128 v[152:155], v7 offset:20736
    ds_read_b128 v[156:159], v7 offset:21760
    v_mfma_f32_16x16x32_bf16 v[24:27], v[120:123], v[136:139], v[24:27]
    ds_read_b128 v[160:163], v7 offset:22784
    ds_read_b128 v[164:167], v7 offset:26880
    v_mfma_f32_16x16x32_bf16 v[28:31], v[124:127], v[136:139], v[28:31]
    ds_read_b128 v[168:171], v7 offset:27904
    ds_read_b128 v[172:175], v7 offset:28928
    v_mfma_f32_16x16x32_bf16 v[32:35], v[128:131], v[136:139], v[32:35]
    ds_read_b64_tr_b16 v[180:181], v5 offset:20768
    ds_read_b64_tr_b16 v[182:183], v5 offset:21280
    v_mfma_f32_16x16x32_bf16 v[36:39], v[132:135], v[136:139], v[36:39]
    ds_read_b64_tr_b16 v[184:185], v5 offset:20800
    ds_read_b64_tr_b16 v[186:187], v5 offset:21312
    v_mfma_f32_16x16x32_bf16 v[40:43], v[112:115], v[140:143], v[40:43]
    ds_read_b64_tr_b16 v[188:189], v5 offset:20832
    ds_read_b64_tr_b16 v[190:191], v5 offset:21344
    v_mfma_f32_16x16x32_bf16 v[44:47], v[116:119], v[140:143], v[44:47]
    v_mfma_f32_16x16x32_bf16 v[48:51], v[120:123], v[140:143], v[48:51]
    v_mfma_f32_16x16x32_bf16 v[52:55], v[124:127], v[140:143], v[52:55]
    v_mfma_f32_16x16x32_bf16 v[56:59], v[128:131], v[140:143], v[56:59]
    v_mfma_f32_16x16x32_bf16 v[60:63], v[132:135], v[140:143], v[60:63]
    s_waitcnt lgkmcnt(11)
    v_mfma_f32_16x16x32_bf16 v[16:19], v[152:155], v[176:179], v[16:19]
    s_waitcnt lgkmcnt(0)
    v_mfma_f32_16x16x32_bf16 v[20:23], v[156:159], v[176:179], v[20:23]
    s_barrier
    v_mfma_f32_16x16x32_bf16 v[24:27], v[160:163], v[176:179], v[24:27]
    v_mfma_f32_16x16x32_bf16 v[28:31], v[164:167], v[176:179], v[28:31]
    v_mfma_f32_16x16x32_bf16 v[32:35], v[168:171], v[176:179], v[32:35]
    v_mfma_f32_16x16x32_bf16 v[36:39], v[172:175], v[176:179], v[36:39]
    v_mfma_f32_16x16x32_bf16 v[40:43], v[152:155], v[180:183], v[40:43]
    v_mfma_f32_16x16x32_bf16 v[44:47], v[156:159], v[180:183], v[44:47]
    v_max_f32 v16, 0, v16
    v_max_f32 v17, 0, v17
    v_mfma_f32_16x16x32_bf16 v[48:51], v[160:163], v[180:183], v[48:51]
    v_max_f32 v18, 0, v18
    v_max_f32 v19, 0, v19
    v_mfma_f32_16x16x32_bf16 v[52:55], v[164:167], v[180:183], v[52:55]
    v_max_f32 v20, 0, v20
    v_max_f32 v21, 0, v21
    v_mfma_f32_16x16x32_bf16 v[56:59], v[168:171], v[180:183], v[56:59]
    v_max_f32 v22, 0, v22
    v_max_f32 v23, 0, v23
    v_mfma_f32_16x16x32_bf16 v[60:63], v[172:175], v[180:183], v[60:63]
    v_max_f32 v24, 0, v24
    v_max_f32 v25, 0, v25
    v_mfma_f32_16x16x32_bf16 v[64:67], v[112:115], v[144:147], v[64:67]
    v_max_f32 v26, 0, v26
    v_max_f32 v27, 0, v27
    v_mfma_f32_16x16x32_bf16 v[68:71], v[116:119], v[144:147], v[68:71]
    v_mul_f32 v16, v16, v28
    v_mul_f32 v17, v17, v29
    v_mfma_f32_16x16x32_bf16 v[72:75], v[120:123], v[144:147], v[72:75]
    v_mul_f32 v18, v18, v30
    v_mul_f32 v19, v19, v31
    v_mfma_f32_16x16x32_bf16 v[76:79], v[124:127], v[144:147], v[76:79]
    v_mul_f32 v20, v20, v32
    v_mul_f32 v21, v21, v33
    v_mfma_f32_16x16x32_bf16 v[80:83], v[128:131], v[144:147], v[80:83]
    v_mul_f32 v22, v22, v34
    v_mul_f32 v23, v23, v35
    v_mfma_f32_16x16x32_bf16 v[84:87], v[132:135], v[144:147], v[84:87]
    v_mul_f32 v24, v24, v36
    v_mul_f32 v25, v25, v37
    v_mfma_f32_16x16x32_bf16 v[64:67], v[152:155], v[184:187], v[64:67]
    v_mul_f32 v26, v26, v38
    v_mul_f32 v27, v27, v39
    v_mfma_f32_16x16x32_bf16 v[68:71], v[156:159], v[184:187], v[68:71]
    v_cvt_pk_bf16_f32 v28, v16, v17
    v_cvt_pk_bf16_f32 v29, v18, v19
    v_mfma_f32_16x16x32_bf16 v[72:75], v[160:163], v[184:187], v[72:75]
    v_cvt_pk_bf16_f32 v30, v20, v21
    v_cvt_pk_bf16_f32 v31, v22, v23
    v_mfma_f32_16x16x32_bf16 v[76:79], v[164:167], v[184:187], v[76:79]
    buffer_store_dwordx4 v[28:31], v8, s[12:15], s28 offen sc1
    v_cvt_pk_bf16_f32 v232, v24, v25
    v_mfma_f32_16x16x32_bf16 v[80:83], v[168:171], v[184:187], v[80:83]
    v_cvt_pk_bf16_f32 v233, v26, v27
    s_add_u32 s28, s28, 49152
    v_mfma_f32_16x16x32_bf16 v[84:87], v[172:175], v[184:187], v[84:87]
    v_max_f32 v40, 0, v40
    v_max_f32 v41, 0, v41
    v_mfma_f32_16x16x32_bf16 v[88:91], v[112:115], v[148:151], v[88:91]
    v_max_f32 v42, 0, v42
    v_max_f32 v43, 0, v43
    v_mfma_f32_16x16x32_bf16 v[92:95], v[116:119], v[148:151], v[92:95]
    v_max_f32 v44, 0, v44
    v_max_f32 v45, 0, v45
    v_mfma_f32_16x16x32_bf16 v[96:99], v[120:123], v[148:151], v[96:99]
    v_max_f32 v46, 0, v46
    v_max_f32 v47, 0, v47
    v_mfma_f32_16x16x32_bf16 v[100:103], v[124:127], v[148:151], v[100:103]
    v_max_f32 v48, 0, v48
    v_max_f32 v49, 0, v49
    v_mfma_f32_16x16x32_bf16 v[104:107], v[128:131], v[148:151], v[104:107]
    v_max_f32 v50, 0, v50
    v_max_f32 v51, 0, v51
    v_mfma_f32_16x16x32_bf16 v[108:111], v[132:135], v[148:151], v[108:111]
    v_mul_f32 v40, v40, v52
    v_mul_f32 v41, v41, v53
    v_mfma_f32_16x16x32_bf16 v[88:91], v[152:155], v[188:191], v[88:91]
    v_mul_f32 v42, v42, v54
    v_mul_f32 v43, v43, v55
    v_mfma_f32_16x16x32_bf16 v[92:95], v[156:159], v[188:191], v[92:95]
    v_mul_f32 v44, v44, v56
    v_mul_f32 v45, v45, v57
    v_mfma_f32_16x16x32_bf16 v[96:99], v[160:163], v[188:191], v[96:99]
    v_mul_f32 v46, v46, v58
    v_mul_f32 v47, v47, v59
    v_mfma_f32_16x16x32_bf16 v[100:103], v[164:167], v[188:191], v[100:103]
    v_mul_f32 v48, v48, v60
    v_mul_f32 v49, v49, v61
    v_mfma_f32_16x16x32_bf16 v[104:107], v[168:171], v[188:191], v[104:107]
    v_mul_f32 v50, v50, v62
    v_mul_f32 v51, v51, v63
    v_mfma_f32_16x16x32_bf16 v[108:111], v[172:175], v[188:191], v[108:111]
    v_cvt_pk_bf16_f32 v52, v40, v41
    v_cvt_pk_bf16_f32 v53, v42, v43
    v_cvt_pk_bf16_f32 v54, v44, v45
    v_cvt_pk_bf16_f32 v55, v46, v47
    buffer_store_dwordx4 v[52:55], v8, s[12:15], s28 offen sc1
    v_cvt_pk_bf16_f32 v234, v48, v49
    v_cvt_pk_bf16_f32 v235, v50, v51
    s_add_u32 s28, s28, 49152
    v_permlane16_swap_b32 v232, v234
    v_permlane16_swap_b32 v233, v235
    buffer_store_dwordx4 v[232:235], v9, s[12:15], s29 offen sc1
    s_add_u32 s29, s29, 98304
    v_max_f32 v64, 0, v64
    v_max_f32 v65, 0, v65
    v_max_f32 v66, 0, v66
    v_max_f32 v67, 0, v67
    v_max_f32 v68, 0, v68
    v_max_f32 v69, 0, v69
    v_max_f32 v70, 0, v70
    v_max_f32 v71, 0, v71
    v_max_f32 v72, 0, v72
    v_max_f32 v73, 0, v73
    v_max_f32 v74, 0, v74
    v_max_f32 v75, 0, v75
    v_mul_f32 v64, v64, v76
    v_mul_f32 v65, v65, v77
    v_mul_f32 v66, v66, v78
    v_mul_f32 v67, v67, v79
    v_mul_f32 v68, v68, v80
    v_mul_f32 v69, v69, v81
    v_mul_f32 v70, v70, v82
    v_mul_f32 v71, v71, v83
    v_mul_f32 v72, v72, v84
    v_mul_f32 v73, v73, v85
    v_mul_f32 v74, v74, v86
    v_mul_f32 v75, v75, v87
    v_cvt_pk_bf16_f32 v76, v64, v65
    v_cvt_pk_bf16_f32 v77, v66, v67
    v_cvt_pk_bf16_f32 v78, v68, v69
    v_cvt_pk_bf16_f32 v79, v70, v71
    buffer_store_dwordx4 v[76:79], v8, s[12:15], s28 offen sc1
    v_cvt_pk_bf16_f32 v236, v72, v73
    v_cvt_pk_bf16_f32 v237, v74, v75
    s_add_u32 s28, s28, 49152
    v_max_f32 v88, 0, v88
    v_max_f32 v89, 0, v89
    v_max_f32 v90, 0, v90
    v_max_f32 v91, 0, v91
    v_max_f32 v92, 0, v92
    v_max_f32 v93, 0, v93
    v_max_f32 v94, 0, v94
    v_max_f32 v95, 0, v95
    v_max_f32 v96, 0, v96
    v_max_f32 v97, 0, v97
    v_max_f32 v98, 0, v98
    v_max_f32 v99, 0, v99
    v_pk_mul_f32 v[88:89], v[88:89], v[100:101]
    v_pk_mul_f32 v[90:91], v[90:91], v[102:103]
    v_pk_mul_f32 v[92:93], v[92:93], v[104:105]
    v_pk_mul_f32 v[94:95], v[94:95], v[106:107]
    v_pk_mul_f32 v[96:97], v[96:97], v[108:109]
    v_pk_mul_f32 v[98:99], v[98:99], v[110:111]
    v_cvt_pk_bf16_f32 v100, v88, v89
    v_cvt_pk_bf16_f32 v101, v90, v91
    v_cvt_pk_bf16_f32 v102, v92, v93
    v_cvt_pk_bf16_f32 v103, v94, v95
    buffer_store_dwordx4 v[100:103], v8, s[12:15], s28 offen sc1
    v_cvt_pk_bf16_f32 v238, v96, v97
    v_cvt_pk_bf16_f32 v239, v98, v99
    s_add_u32 s28, s28, 49152
    v_permlane16_swap_b32 v236, v238
    v_permlane16_swap_b32 v237, v239
    buffer_store_dwordx4 v[236:239], v9, s[12:15], s29 offen sc1
    s_add_u32 s29, s29, 98304
    s_mov_b32 s31, s5
    s_lshl_b32 s32, s31, 2
    s_lshl_b32 s27, s25, 1
    s_add_u32 s32, s32, s27
    s_add_u32 s32, s32, s26
    s_xor_b32 s27, s32, 1
    s_mul_i32 s33, s32, 49152
    s_mul_i32 s58, s27, 49152
    s_mul_i32 s27, s26, 5120
    v_add_u32 v14, s27, v8
    v_add_u32 v4, 0x10000, v14
    v_add_u32 v5, 0x20000, v14
    v_lshrrev_b32 v3, 4, v2
    v_and_b32 v12, 15, v2
    v_lshlrev_b32 v6, 10, v3
    v_lshl_add_u32 v6, v12, 1, v6
    s_lshl_b32 s27, s22, 12
    s_add_u32 s27, s27, 102400
    v_mul_u32_u24 v7, 176, v12
    v_lshl_add_u32 v7, v3, 3, v7
    v_add_u32 v7, s27, v7
    s_mov_b32 s28, 0x199a
    v_add_u32 v15, 0, v2
    v_mul_u32_u24 v13, s28, v15
    v_lshrrev_b32 v13, 16, v13
    v_lshlrev_b32 v15, 4, v15
    v_lshl_add_u32 v241, v13, 4, v15
    v_add_u32 v241, s27, v241
    v_mul_u32_u24 v13, 1120, v13
    v_add_u32 v244, v13, v15
    v_add_u32 v15, 64, v2
    v_mul_u32_u24 v13, s28, v15
    v_lshrrev_b32 v13, 16, v13
    v_lshlrev_b32 v15, 4, v15
    v_lshl_add_u32 v242, v13, 4, v15
    v_add_u32 v242, s27, v242
    v_mul_u32_u24 v13, 1120, v13
    v_add_u32 v245, v13, v15
    v_add_u32 v15, 128, v2
    v_mul_u32_u24 v13, s28, v15
    v_lshrrev_b32 v13, 16, v13
    v_lshlrev_b32 v15, 4, v15
    v_lshl_add_u32 v243, v13, 4, v15
    v_add_u32 v243, s27, v243
    v_mul_u32_u24 v13, 1120, v13
    v_add_u32 v246, v13, v15
    v_mul_u32_u24 v9, 81920, v3
    v_lshl_add_u32 v9, v12, 3, v9
    s_add_u32 s36, s16, 0x780000
    s_addc_u32 s37, s17, 0
    s_mov_b32 s38, 0x280000
    s_mov_b32 s39, 0x20000
    s_add_u32 s40, s16, 0x1020000
    s_addc_u32 s41, s17, 0
    s_mov_b32 s42, 0x50000
    s_mov_b32 s43, 0x20000
    s_mov_b32 s44, s6
    s_mov_b32 s45, s7
    s_mov_b32 s46, 0x280000
    s_mov_b32 s47, 0x20000
    v_mov_b32 v10, 1
    v_lshlrev_b32 v13, 7, v2
    s_lshl_b32 s30, s23, 11
    s_lshl_b32 s27, s24, 7
    s_add_u32 s30, s30, s27
    s_lshr_b32 s34, s31, 1
    s_lshl_b32 s34, s34, 11
    v_lshlrev_b32 v11, 7, v2
    s_mul_i32 s56, s63, 0
    s_lshl_b32 s27, s26, 10
    s_add_u32 s56, s56, s27
    s_waitcnt vmcnt(0)
    s_barrier
    s_cmp_lg_u32 s22, 0
    s_cbranch_scc1 K3_NOSIG
    s_mov_b64 exec, 1
    buffer_store_dword v10, v13, s[52:55], s30 offen sc1
    s_mov_b64 exec, -1
K3_NOSIG:
    s_add_u32 s57, s33, s56
    s_add_u32 s59, s58, s56
    ds_read_b128 v[88:91], v14 offset:0
    ds_read_b128 v[92:95], v14 offset:1024
    ds_read_b128 v[96:99], v14 offset:2048
    ds_read_b128 v[100:103], v14 offset:3072
    ds_read_b128 v[104:107], v14 offset:4096
    v_mov_b32 v56, 0
    v_mov_b32 v57, 0
    v_mov_b32 v58, 0
    v_mov_b32 v59, 0
    v_mov_b32 v60, 0
    v_mov_b32 v61, 0
    v_mov_b32 v62, 0
    v_mov_b32 v63, 0
    v_mov_b32 v64, 0
    v_mov_b32 v65, 0
    v_mov_b32 v66, 0
    v_mov_b32 v67, 0
    v_mov_b32 v68, 0
    v_mov_b32 v69, 0
    v_mov_b32 v70, 0
    v_mov_b32 v71, 0
    v_mov_b32 v72, 0
    v_mov_b32 v73, 0
    v_mov_b32 v74, 0
    v_mov_b32 v75, 0
    s_lshr_b32 s27, s32, 3
    s_mul_i32 s27, s27, 163840
    s_mul_i32 s28, s20, 20480
    s_add_u32 s27, s27, s28
    s_and_b32 s28, s32, 7
    s_lshl_b32 s28, s28, 5
    s_add_u32 s27, s27, s28
    buffer_load_short_d16_hi v56, v6, s[36:39], s27 offen offset:0
    buffer_load_short_d16_hi v57, v6, s[36:39], s27 offen offset:256
    buffer_load_short_d16_hi v58, v6, s[36:39], s27 offen offset:512
    buffer_load_short_d16_hi v59, v6, s[36:39], s27 offen offset:768
    s_add_u32 s27, s27, 4096
    buffer_load_short_d16_hi v60, v6, s[36:39], s27 offen offset:0
    buffer_load_short_d16_hi v61, v6, s[36:39], s27 offen offset:256
    buffer_load_short_d16_hi v62, v6, s[36:39], s27 offen offset:512
    buffer_load_short_d16_hi v63, v6, s[36:39], s27 offen offset:768
    s_add_u32 s27, s27, 4096
    buffer_load_short_d16_hi v64, v6, s[36:39], s27 offen offset:0
    buffer_load_short_d16_hi v65, v6, s[36:39], s27 offen offset:256
    buffer_load_short_d16_hi v66, v6, s[36:39], s27 offen offset:512
    buffer_load_short_d16_hi v67, v6, s[36:39], s27 offen offset:768
    s_add_u32 s27, s27, 4096
    buffer_load_short_d16_hi v68, v6, s[36:39], s27 offen offset:0
    buffer_load_short_d16_hi v69, v6, s[36:39], s27 offen offset:256
    buffer_load_short_d16_hi v70, v6, s[36:39], s27 offen offset:512
    buffer_load_short_d16_hi v71, v6, s[36:39], s27 offen offset:768
    s_add_u32 s27, s27, 4096
    buffer_load_short_d16_hi v72, v6, s[36:39], s27 offen offset:0
    buffer_load_short_d16_hi v73, v6, s[36:39], s27 offen offset:256
    buffer_load_short_d16_hi v74, v6, s[36:39], s27 offen offset:512
    buffer_load_short_d16_hi v75, v6, s[36:39], s27 offen offset:768
    s_add_u32 s27, s27, 4096
    s_cmp_lg_u32 s22, 0
    s_cbranch_scc1 K3_POLLX
    s_mov_b64 exec, 0xffff
    s_mov_b32 s35, 0
K3_POLL:
    s_sleep 4
    buffer_load_dword v12, v11, s[52:55], s34 offen sc1
    s_add_u32 s35, s35, 1
    s_cmp_ge_u32 s35, 200000
    s_cbranch_scc1 K3_POLLD
    s_waitcnt vmcnt(0)
    v_cmp_ne_u32 vcc, 1, v12
    s_cbranch_vccnz K3_POLL
K3_POLLD:
    s_mov_b64 exec, -1
K3_POLLX:
    s_barrier
    buffer_load_dwordx4 v[128:131], v8, s[12:15], s57 offen offset:0 sc1
    buffer_load_dwordx4 v[132:135], v8, s[12:15], s59 offen offset:0 sc1
    buffer_load_dwordx4 v[136:139], v8, s[12:15], s57 offen offset:2048 sc1
    s_add_u32 s57, s57, 4096
    buffer_load_dwordx4 v[140:143], v8, s[12:15], s59 offen offset:2048 sc1
    s_add_u32 s59, s59, 4096
    buffer_load_dwordx4 v[144:147], v8, s[12:15], s57 offen offset:0 sc1
    buffer_load_dwordx4 v[148:151], v8, s[12:15], s59 offen offset:0 sc1
    buffer_load_dwordx4 v[152:155], v8, s[12:15], s57 offen offset:2048 sc1
    s_add_u32 s57, s57, 4096
    buffer_load_dwordx4 v[156:159], v8, s[12:15], s59 offen offset:2048 sc1
    s_add_u32 s59, s59, 4096
    buffer_load_dwordx4 v[160:163], v8, s[12:15], s57 offen offset:0 sc1
    buffer_load_dwordx4 v[164:167], v8, s[12:15], s59 offen offset:0 sc1
    buffer_load_dwordx4 v[168:171], v8, s[12:15], s57 offen offset:2048 sc1
    s_add_u32 s57, s57, 4096
    buffer_load_dwordx4 v[172:175], v8, s[12:15], s59 offen offset:2048 sc1
    s_add_u32 s59, s59, 4096
    s_waitcnt vmcnt(10)
    s_waitcnt lgkmcnt(4)
    v_mfma_f32_16x16x32_bf16 v[16:19], v[88:91], v[128:131], 0
    ds_read_b128 v[108:111], v14 offset:10240
    v_mfma_f32_16x16x32_bf16 v[36:39], v[88:91], v[132:135], 0
    ds_read_b128 v[112:115], v14 offset:11264
    s_waitcnt lgkmcnt(5)
    v_mfma_f32_16x16x32_bf16 v[40:43], v[92:95], v[132:135], 0
    ds_read_b128 v[116:119], v14 offset:12288
    v_mfma_f32_16x16x32_bf16 v[20:23], v[92:95], v[128:131], 0
    ds_read_b128 v[120:123], v14 offset:13312
    s_waitcnt lgkmcnt(6)
    v_mfma_f32_16x16x32_bf16 v[24:27], v[96:99], v[128:131], 0
    ds_read_b128 v[124:127], v14 offset:14336
    v_mfma_f32_16x16x32_bf16 v[44:47], v[96:99], v[132:135], 0
    buffer_load_dwordx4 v[176:179], v8, s[12:15], s57 offen offset:0 sc1
    s_waitcnt lgkmcnt(6)
    v_mfma_f32_16x16x32_bf16 v[48:51], v[100:103], v[132:135], 0
    v_mfma_f32_16x16x32_bf16 v[28:31], v[100:103], v[128:131], 0
    buffer_load_dwordx4 v[180:183], v8, s[12:15], s59 offen offset:0 sc1
    s_waitcnt lgkmcnt(5)
    v_mfma_f32_16x16x32_bf16 v[32:35], v[104:107], v[128:131], 0
    v_mfma_f32_16x16x32_bf16 v[52:55], v[104:107], v[132:135], 0
    s_waitcnt vmcnt(10)
    s_waitcnt lgkmcnt(4)
    v_mfma_f32_16x16x32_bf16 v[16:19], v[108:111], v[136:139], v[16:19]
    ds_read_b128 v[88:91], v14 offset:20480
    v_mfma_f32_16x16x32_bf16 v[36:39], v[108:111], v[140:143], v[36:39]
    ds_read_b128 v[92:95], v14 offset:21504
    s_waitcnt lgkmcnt(5)
    v_mfma_f32_16x16x32_bf16 v[40:43], v[112:115], v[140:143], v[40:43]
    ds_read_b128 v[96:99], v14 offset:22528
    v_mfma_f32_16x16x32_bf16 v[20:23], v[112:115], v[136:139], v[20:23]
    ds_read_b128 v[100:103], v14 offset:23552
    s_waitcnt lgkmcnt(6)
    v_mfma_f32_16x16x32_bf16 v[24:27], v[116:119], v[136:139], v[24:27]
    ds_read_b128 v[104:107], v14 offset:24576
    v_mfma_f32_16x16x32_bf16 v[44:47], v[116:119], v[140:143], v[44:47]
    buffer_load_dwordx4 v[184:187], v8, s[12:15], s57 offen offset:2048 sc1
    s_add_u32 s57, s57, 4096
    s_waitcnt lgkmcnt(6)
    v_mfma_f32_16x16x32_bf16 v[48:51], v[120:123], v[140:143], v[48:51]
    v_mfma_f32_16x16x32_bf16 v[28:31], v[120:123], v[136:139], v[28:31]
    buffer_load_dwordx4 v[188:191], v8, s[12:15], s59 offen offset:2048 sc1
    s_add_u32 s59, s59, 4096
    s_waitcnt lgkmcnt(5)
    v_mfma_f32_16x16x32_bf16 v[32:35], v[124:127], v[136:139], v[32:35]
    v_mfma_f32_16x16x32_bf16 v[52:55], v[124:127], v[140:143], v[52:55]
    s_waitcnt vmcnt(10)
    s_waitcnt lgkmcnt(4)
    v_mfma_f32_16x16x32_bf16 v[16:19], v[88:91], v[144:147], v[16:19]
    ds_read_b128 v[108:111], v14 offset:30720
    v_mfma_f32_16x16x32_bf16 v[36:39], v[88:91], v[148:151], v[36:39]
    ds_read_b128 v[112:115], v14 offset:31744
    s_waitcnt lgkmcnt(5)
    v_mfma_f32_16x16x32_bf16 v[40:43], v[92:95], v[148:151], v[40:43]
    ds_read_b128 v[116:119], v14 offset:32768
    v_mfma_f32_16x16x32_bf16 v[20:23], v[92:95], v[144:147], v[20:23]
    ds_read_b128 v[120:123], v14 offset:33792
    s_waitcnt lgkmcnt(6)
    v_mfma_f32_16x16x32_bf16 v[24:27], v[96:99], v[144:147], v[24:27]
    ds_read_b128 v[124:127], v14 offset:34816
    v_mfma_f32_16x16x32_bf16 v[44:47], v[96:99], v[148:151], v[44:47]
    buffer_load_dwordx4 v[128:131], v8, s[12:15], s57 offen offset:0 sc1
    s_waitcnt lgkmcnt(6)
    v_mfma_f32_16x16x32_bf16 v[48:51], v[100:103], v[148:151], v[48:51]
    v_mfma_f32_16x16x32_bf16 v[28:31], v[100:103], v[144:147], v[28:31]
    buffer_load_dwordx4 v[132:135], v8, s[12:15], s59 offen offset:0 sc1
    s_waitcnt lgkmcnt(5)
    v_mfma_f32_16x16x32_bf16 v[32:35], v[104:107], v[144:147], v[32:35]
    v_mfma_f32_16x16x32_bf16 v[52:55], v[104:107], v[148:151], v[52:55]
    s_waitcnt vmcnt(10)
    s_waitcnt lgkmcnt(4)
    s_waitcnt lgkmcnt(0)
    v_mfma_f32_16x16x32_bf16 v[16:19], v[108:111], v[152:155], v[16:19]
    s_barrier
    ds_read_b128 v[88:91], v14 offset:40960
    v_mfma_f32_16x16x32_bf16 v[36:39], v[108:111], v[156:159], v[36:39]
    ds_read_b128 v[92:95], v14 offset:41984
    v_mfma_f32_16x16x32_bf16 v[40:43], v[112:115], v[156:159], v[40:43]
    ds_read_b128 v[96:99], v14 offset:43008
    v_mfma_f32_16x16x32_bf16 v[20:23], v[112:115], v[152:155], v[20:23]
    ds_read_b128 v[100:103], v14 offset:44032
    v_mfma_f32_16x16x32_bf16 v[24:27], v[116:119], v[152:155], v[24:27]
    ds_read_b128 v[104:107], v14 offset:45056
    v_mfma_f32_16x16x32_bf16 v[44:47], v[116:119], v[156:159], v[44:47]
    buffer_load_dwordx4 v[136:139], v8, s[12:15], s57 offen offset:2048 sc1
    s_add_u32 s57, s57, 4096
    v_mfma_f32_16x16x32_bf16 v[48:51], v[120:123], v[156:159], v[48:51]
    v_mfma_f32_16x16x32_bf16 v[28:31], v[120:123], v[152:155], v[28:31]
    buffer_load_dwordx4 v[140:143], v8, s[12:15], s59 offen offset:2048 sc1
    s_add_u32 s59, s59, 4096
    v_mfma_f32_16x16x32_bf16 v[32:35], v[124:127], v[152:155], v[32:35]
    v_mfma_f32_16x16x32_bf16 v[52:55], v[124:127], v[156:159], v[52:55]
    s_waitcnt vmcnt(10)
    s_waitcnt lgkmcnt(4)
    v_mfma_f32_16x16x32_bf16 v[16:19], v[88:91], v[160:163], v[16:19]
    ds_read_b128 v[108:111], v14 offset:51200
    v_mfma_f32_16x16x32_bf16 v[36:39], v[88:91], v[164:167], v[36:39]
    ds_read_b128 v[112:115], v14 offset:52224
    s_waitcnt lgkmcnt(5)
    v_mfma_f32_16x16x32_bf16 v[40:43], v[92:95], v[164:167], v[40:43]
    ds_read_b128 v[116:119], v14 offset:53248
    v_mfma_f32_16x16x32_bf16 v[20:23], v[92:95], v[160:163], v[20:23]
    ds_read_b128 v[120:123], v14 offset:54272
    s_waitcnt lgkmcnt(6)
    v_mfma_f32_16x16x32_bf16 v[24:27], v[96:99], v[160:163], v[24:27]
    ds_read_b128 v[124:127], v14 offset:55296
    v_mfma_f32_16x16x32_bf16 v[44:47], v[96:99], v[164:167], v[44:47]
    buffer_load_dwordx4 v[144:147], v8, s[12:15], s57 offen offset:0 sc1
    s_waitcnt lgkmcnt(6)
    v_mfma_f32_16x16x32_bf16 v[48:51], v[100:103], v[164:167], v[48:51]
    v_mfma_f32_16x16x32_bf16 v[28:31], v[100:103], v[160:163], v[28:31]
    buffer_load_dwordx4 v[148:151], v8, s[12:15], s59 offen offset:0 sc1
    s_waitcnt lgkmcnt(5)
    v_mfma_f32_16x16x32_bf16 v[32:35], v[104:107], v[160:163], v[32:35]
    v_mfma_f32_16x16x32_bf16 v[52:55], v[104:107], v[164:167], v[52:55]
    s_lshl_b32 s29, s32, 7
    buffer_load_dwordx2 v[76:77], v9, s[40:43], s29 offen sc1
    s_add_u32 s29, s29, 16384
    buffer_load_dwordx2 v[78:79], v9, s[40:43], s29 offen sc1
    s_add_u32 s29, s29, 16384
    buffer_load_dwordx2 v[80:81], v9, s[40:43], s29 offen sc1
    s_add_u32 s29, s29, 16384
    buffer_load_dwordx2 v[82:83], v9, s[40:43], s29 offen sc1
    s_add_u32 s29, s29, 16384
    buffer_load_dwordx2 v[84:85], v9, s[40:43], s29 offen sc1
    s_add_u32 s29, s29, 16384
    s_waitcnt vmcnt(15)
    s_waitcnt lgkmcnt(4)
    v_mfma_f32_16x16x32_bf16 v[16:19], v[108:111], v[168:171], v[16:19]
    ds_read_b128 v[88:91], v14 offset:61440
    v_mfma_f32_16x16x32_bf16 v[36:39], v[108:111], v[172:175], v[36:39]
    ds_read_b128 v[92:95], v14 offset:62464
    s_waitcnt lgkmcnt(5)
    v_mfma_f32_16x16x32_bf16 v[40:43], v[112:115], v[172:175], v[40:43]
    ds_read_b128 v[96:99], v14 offset:63488
    v_mfma_f32_16x16x32_bf16 v[20:23], v[112:115], v[168:171], v[20:23]
    ds_read_b128 v[100:103], v14 offset:64512
    s_waitcnt lgkmcnt(6)
    v_mfma_f32_16x16x32_bf16 v[24:27], v[116:119], v[168:171], v[24:27]
    ds_read_b128 v[104:107], v4 offset:0
    v_mfma_f32_16x16x32_bf16 v[44:47], v[116:119], v[172:175], v[44:47]
    buffer_load_dwordx4 v[152:155], v8, s[12:15], s57 offen offset:2048 sc1
    s_add_u32 s57, s57, 4096
    s_waitcnt lgkmcnt(6)
    v_mfma_f32_16x16x32_bf16 v[48:51], v[120:123], v[172:175], v[48:51]
    v_mfma_f32_16x16x32_bf16 v[28:31], v[120:123], v[168:171], v[28:31]
    buffer_load_dwordx4 v[156:159], v8, s[12:15], s59 offen offset:2048 sc1
    s_add_u32 s59, s59, 4096
    s_waitcnt lgkmcnt(5)
    v_mfma_f32_16x16x32_bf16 v[32:35], v[124:127], v[168:171], v[32:35]
    v_mfma_f32_16x16x32_bf16 v[52:55], v[124:127], v[172:175], v[52:55]
    s_waitcnt vmcnt(15)
    s_waitcnt lgkmcnt(4)
    v_mfma_f32_16x16x32_bf16 v[16:19], v[88:91], v[176:179], v[16:19]
    ds_read_b128 v[108:111], v4 offset:6144
    v_mfma_f32_16x16x32_bf16 v[36:39], v[88:91], v[180:183], v[36:39]
    ds_read_b128 v[112:115], v4 offset:7168
    s_waitcnt lgkmcnt(5)
    v_mfma_f32_16x16x32_bf16 v[40:43], v[92:95], v[180:183], v[40:43]
    ds_read_b128 v[116:119], v4 offset:8192
    v_mfma_f32_16x16x32_bf16 v[20:23], v[92:95], v[176:179], v[20:23]
    ds_read_b128 v[120:123], v4 offset:9216
    s_waitcnt lgkmcnt(6)
    v_mfma_f32_16x16x32_bf16 v[24:27], v[96:99], v[176:179], v[24:27]
    ds_read_b128 v[124:127], v4 offset:10240
    v_mfma_f32_16x16x32_bf16 v[44:47], v[96:99], v[180:183], v[44:47]
    buffer_load_dwordx4 v[160:163], v8, s[12:15], s57 offen offset:0 sc1
    s_waitcnt lgkmcnt(6)
    v_mfma_f32_16x16x32_bf16 v[48:51], v[100:103], v[180:183], v[48:51]
    v_mfma_f32_16x16x32_bf16 v[28:31], v[100:103], v[176:179], v[28:31]
    buffer_load_dwordx4 v[164:167], v8, s[12:15], s59 offen offset:0 sc1
    s_waitcnt lgkmcnt(5)
    v_mfma_f32_16x16x32_bf16 v[32:35], v[104:107], v[176:179], v[32:35]
    v_mfma_f32_16x16x32_bf16 v[52:55], v[104:107], v[180:183], v[52:55]
    s_waitcnt vmcnt(15)
    s_waitcnt lgkmcnt(4)
    s_waitcnt lgkmcnt(0)
    v_mfma_f32_16x16x32_bf16 v[16:19], v[108:111], v[184:187], v[16:19]
    s_barrier
    ds_read_b128 v[88:91], v4 offset:16384
    v_mfma_f32_16x16x32_bf16 v[36:39], v[108:111], v[188:191], v[36:39]
    ds_read_b128 v[92:95], v4 offset:17408
    v_mfma_f32_16x16x32_bf16 v[40:43], v[112:115], v[188:191], v[40:43]
    ds_read_b128 v[96:99], v4 offset:18432
    v_mfma_f32_16x16x32_bf16 v[20:23], v[112:115], v[184:187], v[20:23]
    ds_read_b128 v[100:103], v4 offset:19456
    v_mfma_f32_16x16x32_bf16 v[24:27], v[116:119], v[184:187], v[24:27]
    ds_read_b128 v[104:107], v4 offset:20480
    v_mfma_f32_16x16x32_bf16 v[44:47], v[116:119], v[188:191], v[44:47]
    buffer_load_dwordx4 v[168:171], v8, s[12:15], s57 offen offset:2048 sc1
    s_add_u32 s57, s57, 4096
    v_mfma_f32_16x16x32_bf16 v[48:51], v[120:123], v[188:191], v[48:51]
    v_mfma_f32_16x16x32_bf16 v[28:31], v[120:123], v[184:187], v[28:31]
    buffer_load_dwordx4 v[172:175], v8, s[12:15], s59 offen offset:2048 sc1
    s_add_u32 s59, s59, 4096
    v_mfma_f32_16x16x32_bf16 v[32:35], v[124:127], v[184:187], v[32:35]
    v_mfma_f32_16x16x32_bf16 v[52:55], v[124:127], v[188:191], v[52:55]
    s_waitcnt vmcnt(15)
    s_waitcnt lgkmcnt(4)
    v_mfma_f32_16x16x32_bf16 v[16:19], v[88:91], v[128:131], v[16:19]
    ds_read_b128 v[108:111], v4 offset:26624
    v_mfma_f32_16x16x32_bf16 v[36:39], v[88:91], v[132:135], v[36:39]
    ds_read_b128 v[112:115], v4 offset:27648
    s_waitcnt lgkmcnt(5)
    v_mfma_f32_16x16x32_bf16 v[40:43], v[92:95], v[132:135], v[40:43]
    ds_read_b128 v[116:119], v4 offset:28672
    v_mfma_f32_16x16x32_bf16 v[20:23], v[92:95], v[128:131], v[20:23]
    ds_read_b128 v[120:123], v4 offset:29696
    s_waitcnt lgkmcnt(6)
    v_mfma_f32_16x16x32_bf16 v[24:27], v[96:99], v[128:131], v[24:27]
    ds_read_b128 v[124:127], v4 offset:30720
    v_mfma_f32_16x16x32_bf16 v[44:47], v[96:99], v[132:135], v[44:47]
    buffer_load_dwordx4 v[176:179], v8, s[12:15], s57 offen offset:0 sc1
    s_waitcnt lgkmcnt(6)
    v_mfma_f32_16x16x32_bf16 v[48:51], v[100:103], v[132:135], v[48:51]
    v_mfma_f32_16x16x32_bf16 v[28:31], v[100:103], v[128:131], v[28:31]
    buffer_load_dwordx4 v[180:183], v8, s[12:15], s59 offen offset:0 sc1
    s_waitcnt lgkmcnt(5)
    v_mfma_f32_16x16x32_bf16 v[32:35], v[104:107], v[128:131], v[32:35]
    v_mfma_f32_16x16x32_bf16 v[52:55], v[104:107], v[132:135], v[52:55]
    s_waitcnt vmcnt(15)
    s_waitcnt lgkmcnt(4)
    v_mfma_f32_16x16x32_bf16 v[16:19], v[108:111], v[136:139], v[16:19]
    ds_read_b128 v[88:91], v4 offset:36864
    v_mfma_f32_16x16x32_bf16 v[36:39], v[108:111], v[140:143], v[36:39]
    ds_read_b128 v[92:95], v4 offset:37888
    s_waitcnt lgkmcnt(5)
    v_mfma_f32_16x16x32_bf16 v[40:43], v[112:115], v[140:143], v[40:43]
    ds_read_b128 v[96:99], v4 offset:38912
    v_mfma_f32_16x16x32_bf16 v[20:23], v[112:115], v[136:139], v[20:23]
    ds_read_b128 v[100:103], v4 offset:39936
    s_waitcnt lgkmcnt(6)
    v_mfma_f32_16x16x32_bf16 v[24:27], v[116:119], v[136:139], v[24:27]
    ds_read_b128 v[104:107], v4 offset:40960
    v_mfma_f32_16x16x32_bf16 v[44:47], v[116:119], v[140:143], v[44:47]
    buffer_load_dwordx4 v[184:187], v8, s[12:15], s57 offen offset:2048 sc1
    s_add_u32 s57, s57, 4096
    s_waitcnt lgkmcnt(6)
    v_mfma_f32_16x16x32_bf16 v[48:51], v[120:123], v[140:143], v[48:51]
    v_mfma_f32_16x16x32_bf16 v[28:31], v[120:123], v[136:139], v[28:31]
    buffer_load_dwordx4 v[188:191], v8, s[12:15], s59 offen offset:2048 sc1
    s_add_u32 s59, s59, 4096
    s_waitcnt lgkmcnt(5)
    v_mfma_f32_16x16x32_bf16 v[32:35], v[124:127], v[136:139], v[32:35]
    v_mfma_f32_16x16x32_bf16 v[52:55], v[124:127], v[140:143], v[52:55]
    s_waitcnt vmcnt(15)
    s_waitcnt lgkmcnt(4)
    v_mfma_f32_16x16x32_bf16 v[16:19], v[88:91], v[144:147], v[16:19]
    ds_read_b128 v[108:111], v4 offset:47104
    v_mfma_f32_16x16x32_bf16 v[36:39], v[88:91], v[148:151], v[36:39]
    ds_read_b128 v[112:115], v4 offset:48128
    s_waitcnt lgkmcnt(5)
    v_mfma_f32_16x16x32_bf16 v[40:43], v[92:95], v[148:151], v[40:43]
    ds_read_b128 v[116:119], v4 offset:49152
    v_mfma_f32_16x16x32_bf16 v[20:23], v[92:95], v[144:147], v[20:23]
    ds_read_b128 v[120:123], v4 offset:50176
    s_waitcnt lgkmcnt(6)
    v_mfma_f32_16x16x32_bf16 v[24:27], v[96:99], v[144:147], v[24:27]
    ds_read_b128 v[124:127], v4 offset:51200
    v_mfma_f32_16x16x32_bf16 v[44:47], v[96:99], v[148:151], v[44:47]
    buffer_load_dwordx4 v[128:131], v8, s[12:15], s57 offen offset:0 sc1
    s_waitcnt lgkmcnt(6)
    v_mfma_f32_16x16x32_bf16 v[48:51], v[100:103], v[148:151], v[48:51]
    v_mfma_f32_16x16x32_bf16 v[28:31], v[100:103], v[144:147], v[28:31]
    buffer_load_dwordx4 v[132:135], v8, s[12:15], s59 offen offset:0 sc1
    s_waitcnt lgkmcnt(5)
    v_mfma_f32_16x16x32_bf16 v[32:35], v[104:107], v[144:147], v[32:35]
    v_mfma_f32_16x16x32_bf16 v[52:55], v[104:107], v[148:151], v[52:55]
    s_waitcnt vmcnt(10)
    s_waitcnt lgkmcnt(4)
    v_mfma_f32_16x16x32_bf16 v[16:19], v[108:111], v[152:155], v[16:19]
    ds_read_b128 v[88:91], v4 offset:57344
    v_mfma_f32_16x16x32_bf16 v[36:39], v[108:111], v[156:159], v[36:39]
    ds_read_b128 v[92:95], v4 offset:58368
    s_waitcnt lgkmcnt(5)
    v_mfma_f32_16x16x32_bf16 v[40:43], v[112:115], v[156:159], v[40:43]
    ds_read_b128 v[96:99], v4 offset:59392
    v_mfma_f32_16x16x32_bf16 v[20:23], v[112:115], v[152:155], v[20:23]
    ds_read_b128 v[100:103], v4 offset:60416
    s_waitcnt lgkmcnt(6)
    v_mfma_f32_16x16x32_bf16 v[24:27], v[116:119], v[152:155], v[24:27]
    ds_read_b128 v[104:107], v4 offset:61440
    v_mfma_f32_16x16x32_bf16 v[44:47], v[116:119], v[156:159], v[44:47]
    buffer_load_dwordx4 v[136:139], v8, s[12:15], s57 offen offset:2048 sc1
    s_add_u32 s57, s57, 4096
    s_waitcnt lgkmcnt(6)
    v_mfma_f32_16x16x32_bf16 v[48:51], v[120:123], v[156:159], v[48:51]
    v_mfma_f32_16x16x32_bf16 v[28:31], v[120:123], v[152:155], v[28:31]
    buffer_load_dwordx4 v[140:143], v8, s[12:15], s59 offen offset:2048 sc1
    s_add_u32 s59, s59, 4096
    s_waitcnt lgkmcnt(5)
    v_mfma_f32_16x16x32_bf16 v[32:35], v[124:127], v[152:155], v[32:35]
    v_mfma_f32_16x16x32_bf16 v[52:55], v[124:127], v[156:159], v[52:55]
    s_waitcnt vmcnt(10)
    s_waitcnt lgkmcnt(4)
    v_mfma_f32_16x16x32_bf16 v[16:19], v[88:91], v[160:163], v[16:19]
    ds_read_b128 v[108:111], v5 offset:2048
    v_mfma_f32_16x16x32_bf16 v[36:39], v[88:91], v[164:167], v[36:39]
    ds_read_b128 v[112:115], v5 offset:3072
    s_waitcnt lgkmcnt(5)
    v_mfma_f32_16x16x32_bf16 v[40:43], v[92:95], v[164:167], v[40:43]
    ds_read_b128 v[116:119], v5 offset:4096
    v_mfma_f32_16x16x32_bf16 v[20:23], v[92:95], v[160:163], v[20:23]
    ds_read_b128 v[120:123], v5 offset:5120
    s_waitcnt lgkmcnt(6)
    v_mfma_f32_16x16x32_bf16 v[24:27], v[96:99], v[160:163], v[24:27]
    ds_read_b128 v[124:127], v5 offset:6144
    v_mfma_f32_16x16x32_bf16 v[44:47], v[96:99], v[164:167], v[44:47]
    buffer_load_dwordx4 v[144:147], v8, s[12:15], s57 offen offset:0 sc1
    s_waitcnt lgkmcnt(6)
    v_mfma_f32_16x16x32_bf16 v[48:51], v[100:103], v[164:167], v[48:51]
    v_add_f32 v76, v76, v78
    v_mfma_f32_16x16x32_bf16 v[28:31], v[100:103], v[160:163], v[28:31]
    buffer_load_dwordx4 v[148:151], v8, s[12:15], s59 offen offset:0 sc1
    s_waitcnt lgkmcnt(5)
    v_mfma_f32_16x16x32_bf16 v[32:35], v[104:107], v[160:163], v[32:35]
    v_add_f32 v77, v77, v79
    v_mfma_f32_16x16x32_bf16 v[52:55], v[104:107], v[164:167], v[52:55]
    v_add_f32 v76, v76, v80
    s_waitcnt vmcnt(10)
    s_waitcnt lgkmcnt(4)
    v_mfma_f32_16x16x32_bf16 v[16:19], v[108:111], v[168:171], v[16:19]
    ds_read_b128 v[88:91], v5 offset:12288
    v_mfma_f32_16x16x32_bf16 v[36:39], v[108:111], v[172:175], v[36:39]
    ds_read_b128 v[92:95], v5 offset:13312
    s_waitcnt lgkmcnt(5)
    v_mfma_f32_16x16x32_bf16 v[40:43], v[112:115], v[172:175], v[40:43]
    ds_read_b128 v[96:99], v5 offset:14336
    v_mfma_f32_16x16x32_bf16 v[20:23], v[112:115], v[168:171], v[20:23]
    ds_read_b128 v[100:103], v5 offset:15360
    s_waitcnt lgkmcnt(6)
    v_mfma_f32_16x16x32_bf16 v[24:27], v[116:119], v[168:171], v[24:27]
    ds_read_b128 v[104:107], v5 offset:16384
    v_mfma_f32_16x16x32_bf16 v[44:47], v[116:119], v[172:175], v[44:47]
    buffer_load_dwordx4 v[152:155], v8, s[12:15], s57 offen offset:2048 sc1
    s_add_u32 s57, s57, 4096
    s_waitcnt lgkmcnt(6)
    v_mfma_f32_16x16x32_bf16 v[48:51], v[120:123], v[172:175], v[48:51]
    v_add_f32 v77, v77, v81
    v_mfma_f32_16x16x32_bf16 v[28:31], v[120:123], v[168:171], v[28:31]
    buffer_load_dwordx4 v[156:159], v8, s[12:15], s59 offen offset:2048 sc1
    s_add_u32 s59, s59, 4096
    s_waitcnt lgkmcnt(5)
    v_mfma_f32_16x16x32_bf16 v[32:35], v[124:127], v[168:171], v[32:35]
    v_add_f32 v76, v76, v82
    v_mfma_f32_16x16x32_bf16 v[52:55], v[124:127], v[172:175], v[52:55]
    v_add_f32 v77, v77, v83
    s_waitcnt vmcnt(10)
    s_waitcnt lgkmcnt(4)
    v_mfma_f32_16x16x32_bf16 v[16:19], v[88:91], v[176:179], v[16:19]
    ds_read_b128 v[108:111], v5 offset:22528
    v_mfma_f32_16x16x32_bf16 v[36:39], v[88:91], v[180:183], v[36:39]
    ds_read_b128 v[112:115], v5 offset:23552
    s_waitcnt lgkmcnt(5)
    v_mfma_f32_16x16x32_bf16 v[40:43], v[92:95], v[180:183], v[40:43]
    ds_read_b128 v[116:119], v5 offset:24576
    v_mfma_f32_16x16x32_bf16 v[20:23], v[92:95], v[176:179], v[20:23]
    ds_read_b128 v[120:123], v5 offset:25600
    s_waitcnt lgkmcnt(6)
    v_mfma_f32_16x16x32_bf16 v[24:27], v[96:99], v[176:179], v[24:27]
    ds_read_b128 v[124:127], v5 offset:26624
    v_mfma_f32_16x16x32_bf16 v[44:47], v[96:99], v[180:183], v[44:47]
    buffer_load_dwordx4 v[160:163], v8, s[12:15], s57 offen offset:0 sc1
    s_waitcnt lgkmcnt(6)
    v_mfma_f32_16x16x32_bf16 v[48:51], v[100:103], v[180:183], v[48:51]
    v_add_f32 v76, v76, v84
    v_mfma_f32_16x16x32_bf16 v[28:31], v[100:103], v[176:179], v[28:31]
    buffer_load_dwordx4 v[164:167], v8, s[12:15], s59 offen offset:0 sc1
    s_waitcnt lgkmcnt(5)
    v_mfma_f32_16x16x32_bf16 v[32:35], v[104:107], v[176:179], v[32:35]
    v_add_f32 v77, v77, v85
    v_mfma_f32_16x16x32_bf16 v[52:55], v[104:107], v[180:183], v[52:55]
    v_mov_b32 v78, v76
    s_waitcnt vmcnt(10)
    s_waitcnt lgkmcnt(4)
    v_mfma_f32_16x16x32_bf16 v[16:19], v[108:111], v[184:187], v[16:19]
    s_barrier
    ds_read_b128 v[88:91], v14 offset:0
    v_mfma_f32_16x16x32_bf16 v[36:39], v[108:111], v[188:191], v[36:39]
    ds_read_b128 v[92:95], v14 offset:1024
    s_waitcnt lgkmcnt(5)
    v_mfma_f32_16x16x32_bf16 v[40:43], v[112:115], v[188:191], v[40:43]
    ds_read_b128 v[96:99], v14 offset:2048
    v_mfma_f32_16x16x32_bf16 v[20:23], v[112:115], v[184:187], v[20:23]
    ds_read_b128 v[100:103], v14 offset:3072
    s_waitcnt lgkmcnt(6)
    v_mfma_f32_16x16x32_bf16 v[24:27], v[116:119], v[184:187], v[24:27]
    ds_read_b128 v[104:107], v14 offset:4096
    v_mfma_f32_16x16x32_bf16 v[44:47], v[116:119], v[188:191], v[44:47]
    buffer_load_dwordx4 v[168:171], v8, s[12:15], s57 offen offset:2048 sc1
    s_add_u32 s57, s57, 4096
    s_waitcnt lgkmcnt(6)
    v_mfma_f32_16x16x32_bf16 v[48:51], v[120:123], v[188:191], v[48:51]
    v_mov_b32 v79, v77
    v_mfma_f32_16x16x32_bf16 v[28:31], v[120:123], v[184:187], v[28:31]
    buffer_load_dwordx4 v[172:175], v8, s[12:15], s59 offen offset:2048 sc1
    s_add_u32 s59, s59, 4096
    s_waitcnt lgkmcnt(5)
    v_mfma_f32_16x16x32_bf16 v[32:35], v[124:127], v[184:187], v[32:35]
    v_permlane32_swap_b32 v76, v78
    v_mfma_f32_16x16x32_bf16 v[52:55], v[124:127], v[188:191], v[52:55]
    v_permlane32_swap_b32 v77, v79
    s_waitcnt vmcnt(10)
    s_waitcnt lgkmcnt(4)
    v_mfma_f32_16x16x32_bf16 v[16:19], v[88:91], v[128:131], v[16:19]
    ds_read_b128 v[108:111], v14 offset:10240
    v_mfma_f32_16x16x32_bf16 v[36:39], v[88:91], v[132:135], v[36:39]
    ds_read_b128 v[112:115], v14 offset:11264
    s_waitcnt lgkmcnt(5)
    v_mfma_f32_16x16x32_bf16 v[40:43], v[92:95], v[132:135], v[40:43]
    ds_read_b128 v[116:119], v14 offset:12288
    v_mfma_f32_16x16x32_bf16 v[20:23], v[92:95], v[128:131], v[20:23]
    ds_read_b128 v[120:123], v14 offset:13312
    s_waitcnt lgkmcnt(6)
    v_mfma_f32_16x16x32_bf16 v[24:27], v[96:99], v[128:131], v[24:27]
    ds_read_b128 v[124:127], v14 offset:14336
    v_mfma_f32_16x16x32_bf16 v[44:47], v[96:99], v[132:135], v[44:47]
    buffer_load_dwordx4 v[176:179], v8, s[12:15], s57 offen offset:0 sc1
    s_waitcnt lgkmcnt(6)
    v_mfma_f32_16x16x32_bf16 v[48:51], v[100:103], v[132:135], v[48:51]
    v_add_f32 v76, v76, v78
    v_mfma_f32_16x16x32_bf16 v[28:31], v[100:103], v[128:131], v[28:31]
    buffer_load_dwordx4 v[180:183], v8, s[12:15], s59 offen offset:0 sc1
    s_waitcnt lgkmcnt(5)
    v_mfma_f32_16x16x32_bf16 v[32:35], v[104:107], v[128:131], v[32:35]
    v_add_f32 v77, v77, v79
    v_mfma_f32_16x16x32_bf16 v[52:55], v[104:107], v[132:135], v[52:55]
    v_mov_b32 v78, v76
    s_waitcnt vmcnt(10)
    s_waitcnt lgkmcnt(4)
    v_mfma_f32_16x16x32_bf16 v[16:19], v[108:111], v[136:139], v[16:19]
    ds_read_b128 v[88:91], v14 offset:20480
    v_mfma_f32_16x16x32_bf16 v[36:39], v[108:111], v[140:143], v[36:39]
    ds_read_b128 v[92:95], v14 offset:21504
    s_waitcnt lgkmcnt(5)
    v_mfma_f32_16x16x32_bf16 v[40:43], v[112:115], v[140:143], v[40:43]
    ds_read_b128 v[96:99], v14 offset:22528
    v_mfma_f32_16x16x32_bf16 v[20:23], v[112:115], v[136:139], v[20:23]
    ds_read_b128 v[100:103], v14 offset:23552
    s_waitcnt lgkmcnt(6)
    v_mfma_f32_16x16x32_bf16 v[24:27], v[116:119], v[136:139], v[24:27]
    ds_read_b128 v[104:107], v14 offset:24576
    v_mfma_f32_16x16x32_bf16 v[44:47], v[116:119], v[140:143], v[44:47]
    buffer_load_dwordx4 v[184:187], v8, s[12:15], s57 offen offset:2048 sc1
    s_add_u32 s57, s57, 4096
    s_waitcnt lgkmcnt(6)
    v_mfma_f32_16x16x32_bf16 v[48:51], v[120:123], v[140:143], v[48:51]
    v_mov_b32 v79, v77
    v_mfma_f32_16x16x32_bf16 v[28:31], v[120:123], v[136:139], v[28:31]
    buffer_load_dwordx4 v[188:191], v8, s[12:15], s59 offen offset:2048 sc1
    s_add_u32 s59, s59, 4096
    s_waitcnt lgkmcnt(5)
    v_mfma_f32_16x16x32_bf16 v[32:35], v[124:127], v[136:139], v[32:35]
    v_permlane16_swap_b32 v76, v78
    v_mfma_f32_16x16x32_bf16 v[52:55], v[124:127], v[140:143], v[52:55]
    v_permlane16_swap_b32 v77, v79
    s_waitcnt vmcnt(10)
    s_waitcnt lgkmcnt(4)
    v_mfma_f32_16x16x32_bf16 v[16:19], v[88:91], v[144:147], v[16:19]
    ds_read_b128 v[108:111], v14 offset:30720
    v_mfma_f32_16x16x32_bf16 v[36:39], v[88:91], v[148:151], v[36:39]
    ds_read_b128 v[112:115], v14 offset:31744
    s_waitcnt lgkmcnt(5)
    v_mfma_f32_16x16x32_bf16 v[40:43], v[92:95], v[148:151], v[40:43]
    ds_read_b128 v[116:119], v14 offset:32768
    v_mfma_f32_16x16x32_bf16 v[20:23], v[92:95], v[144:147], v[20:23]
    ds_read_b128 v[120:123], v14 offset:33792
    s_waitcnt lgkmcnt(6)
    v_mfma_f32_16x16x32_bf16 v[24:27], v[96:99], v[144:147], v[24:27]
    ds_read_b128 v[124:127], v14 offset:34816
    v_mfma_f32_16x16x32_bf16 v[44:47], v[96:99], v[148:151], v[44:47]
    s_waitcnt lgkmcnt(6)
    v_mfma_f32_16x16x32_bf16 v[48:51], v[100:103], v[148:151], v[48:51]
    v_add_f32 v76, v76, v78
    v_mfma_f32_16x16x32_bf16 v[28:31], v[100:103], v[144:147], v[28:31]
    s_waitcnt lgkmcnt(5)
    v_mfma_f32_16x16x32_bf16 v[32:35], v[104:107], v[144:147], v[32:35]
    v_add_f32 v77, v77, v79
    v_mfma_f32_16x16x32_bf16 v[52:55], v[104:107], v[148:151], v[52:55]
    v_mul_f32 v76, 0x3acccccd, v76
    s_waitcnt vmcnt(8)
    s_waitcnt lgkmcnt(4)
    v_mfma_f32_16x16x32_bf16 v[16:19], v[108:111], v[152:155], v[16:19]
    s_barrier
    ds_read_b128 v[88:91], v14 offset:40960
    v_mfma_f32_16x16x32_bf16 v[36:39], v[108:111], v[156:159], v[36:39]
    ds_read_b128 v[92:95], v14 offset:41984
    s_waitcnt lgkmcnt(5)
    v_mfma_f32_16x16x32_bf16 v[40:43], v[112:115], v[156:159], v[40:43]
    ds_read_b128 v[96:99], v14 offset:43008
    v_mfma_f32_16x16x32_bf16 v[20:23], v[112:115], v[152:155], v[20:23]
    ds_read_b128 v[100:103], v14 offset:44032
    s_waitcnt lgkmcnt(6)
    v_mfma_f32_16x16x32_bf16 v[24:27], v[116:119], v[152:155], v[24:27]
    ds_read_b128 v[104:107], v14 offset:45056
    v_mfma_f32_16x16x32_bf16 v[44:47], v[116:119], v[156:159], v[44:47]
    s_waitcnt lgkmcnt(6)
    v_mfma_f32_16x16x32_bf16 v[48:51], v[120:123], v[156:159], v[48:51]
    v_mul_f32 v13, 0x3acccccd, v77
    v_mfma_f32_16x16x32_bf16 v[28:31], v[120:123], v[152:155], v[28:31]
    s_waitcnt lgkmcnt(5)
    v_mfma_f32_16x16x32_bf16 v[32:35], v[124:127], v[152:155], v[32:35]
    v_fma_f32 v13, -v76, v76, v13
    v_mfma_f32_16x16x32_bf16 v[52:55], v[124:127], v[156:159], v[52:55]
    v_max_f32 v13, 0, v13
    s_waitcnt vmcnt(6)
    s_waitcnt lgkmcnt(4)
    v_mfma_f32_16x16x32_bf16 v[16:19], v[88:91], v[160:163], v[16:19]
    ds_read_b128 v[108:111], v14 offset:51200
    v_mfma_f32_16x16x32_bf16 v[36:39], v[88:91], v[164:167], v[36:39]
    ds_read_b128 v[112:115], v14 offset:52224
    s_waitcnt lgkmcnt(5)
    v_mfma_f32_16x16x32_bf16 v[40:43], v[92:95], v[164:167], v[40:43]
    ds_read_b128 v[116:119], v14 offset:53248
    v_mfma_f32_16x16x32_bf16 v[20:23], v[92:95], v[160:163], v[20:23]
    ds_read_b128 v[120:123], v14 offset:54272
    s_waitcnt lgkmcnt(6)
    v_mfma_f32_16x16x32_bf16 v[24:27], v[96:99], v[160:163], v[24:27]
    ds_read_b128 v[124:127], v14 offset:55296
    v_mfma_f32_16x16x32_bf16 v[44:47], v[96:99], v[164:167], v[44:47]
    s_waitcnt lgkmcnt(6)
    v_mfma_f32_16x16x32_bf16 v[48:51], v[100:103], v[164:167], v[48:51]
    v_cvt_pk_bf16_f32 v13, v13, v13
    v_mfma_f32_16x16x32_bf16 v[28:31], v[100:103], v[160:163], v[28:31]
    s_waitcnt lgkmcnt(5)
    v_mfma_f32_16x16x32_bf16 v[32:35], v[104:107], v[160:163], v[32:35]
    v_and_b32 v13, 0xffff0000, v13
    v_mfma_f32_16x16x32_bf16 v[52:55], v[104:107], v[164:167], v[52:55]
    v_add_f32 v13, 0x3727c5ac, v13
    s_waitcnt vmcnt(4)
    s_waitcnt lgkmcnt(4)
    v_mfma_f32_16x16x32_bf16 v[16:19], v[108:111], v[168:171], v[16:19]
    ds_read_b128 v[88:91], v14 offset:61440
    v_mfma_f32_16x16x32_bf16 v[36:39], v[108:111], v[172:175], v[36:39]
    ds_read_b128 v[92:95], v14 offset:62464
    s_waitcnt lgkmcnt(5)
    v_mfma_f32_16x16x32_bf16 v[40:43], v[112:115], v[172:175], v[40:43]
    ds_read_b128 v[96:99], v14 offset:63488
    v_mfma_f32_16x16x32_bf16 v[20:23], v[112:115], v[168:171], v[20:23]
    ds_read_b128 v[100:103], v14 offset:64512
    s_waitcnt lgkmcnt(6)
    v_mfma_f32_16x16x32_bf16 v[24:27], v[116:119], v[168:171], v[24:27]
    ds_read_b128 v[104:107], v4 offset:0
    v_mfma_f32_16x16x32_bf16 v[44:47], v[116:119], v[172:175], v[44:47]
    s_waitcnt lgkmcnt(6)
    v_mfma_f32_16x16x32_bf16 v[48:51], v[120:123], v[172:175], v[48:51]
    v_cvt_pk_bf16_f32 v13, v13, v13
    v_mfma_f32_16x16x32_bf16 v[28:31], v[120:123], v[168:171], v[28:31]
    s_waitcnt lgkmcnt(5)
    v_mfma_f32_16x16x32_bf16 v[32:35], v[124:127], v[168:171], v[32:35]
    v_and_b32 v13, 0xffff0000, v13
    v_mfma_f32_16x16x32_bf16 v[52:55], v[124:127], v[172:175], v[52:55]
    v_sqrt_f32 v13, v13
    s_nop 0
    v_cvt_pk_bf16_f32 v13, v13, v13
    v_and_b32 v13, 0xffff0000, v13
    v_rcp_f32 v13, v13
    s_nop 0
    v_mul_f32 v13, v13, v13
    s_mul_i32 s27, s22, 5120
    s_add_u32 s27, s27, 81920
    v_add_u32 v10, s27, v8
    s_xor_b32 s28, s22, 2
    s_mul_i32 s28, s28, 5120
    s_add_u32 s28, s28, 81920
    v_add_u32 v11, s28, v8
    s_waitcnt vmcnt(2)
    s_waitcnt lgkmcnt(4)
    v_mfma_f32_16x16x32_bf16 v[36:39], v[88:91], v[180:183], v[36:39]
    ds_read_b128 v[108:111], v4 offset:6144
    s_waitcnt lgkmcnt(4)
    v_mfma_f32_16x16x32_bf16 v[40:43], v[92:95], v[180:183], v[40:43]
    ds_read_b128 v[112:115], v4 offset:7168
    s_waitcnt lgkmcnt(4)
    v_mfma_f32_16x16x32_bf16 v[44:47], v[96:99], v[180:183], v[44:47]
    ds_read_b128 v[116:119], v4 offset:8192
    s_waitcnt lgkmcnt(4)
    v_mfma_f32_16x16x32_bf16 v[48:51], v[100:103], v[180:183], v[48:51]
    ds_read_b128 v[120:123], v4 offset:9216
    s_waitcnt lgkmcnt(4)
    v_mfma_f32_16x16x32_bf16 v[52:55], v[104:107], v[180:183], v[52:55]
    ds_read_b128 v[124:127], v4 offset:10240
    v_mfma_f32_16x16x32_bf16 v[16:19], v[88:91], v[176:179], v[16:19]
    v_mfma_f32_16x16x32_bf16 v[20:23], v[92:95], v[176:179], v[20:23]
    v_mfma_f32_16x16x32_bf16 v[24:27], v[96:99], v[176:179], v[24:27]
    s_waitcnt vmcnt(0)
    s_waitcnt lgkmcnt(4)
    v_mfma_f32_16x16x32_bf16 v[36:39], v[108:111], v[188:191], v[36:39]
    s_waitcnt lgkmcnt(3)
    v_mfma_f32_16x16x32_bf16 v[40:43], v[112:115], v[188:191], v[40:43]
    s_waitcnt lgkmcnt(2)
    v_mfma_f32_16x16x32_bf16 v[44:47], v[116:119], v[188:191], v[44:47]
    s_waitcnt lgkmcnt(1)
    v_mfma_f32_16x16x32_bf16 v[48:51], v[120:123], v[188:191], v[48:51]
    s_waitcnt lgkmcnt(0)
    v_mfma_f32_16x16x32_bf16 v[52:55], v[124:127], v[188:191], v[52:55]
    v_mfma_f32_16x16x32_bf16 v[28:31], v[100:103], v[176:179], v[28:31]
    v_mfma_f32_16x16x32_bf16 v[32:35], v[104:107], v[176:179], v[32:35]
    ds_write_b128 v10, v[36:39] offset:0
    v_mfma_f32_16x16x32_bf16 v[16:19], v[108:111], v[184:187], v[16:19]
    ds_write_b128 v10, v[40:43] offset:1024
    v_mfma_f32_16x16x32_bf16 v[20:23], v[112:115], v[184:187], v[20:23]
    ds_write_b128 v10, v[44:47] offset:2048
    v_mfma_f32_16x16x32_bf16 v[24:27], v[116:119], v[184:187], v[24:27]
    ds_write_b128 v10, v[48:51] offset:3072
    v_mfma_f32_16x16x32_bf16 v[28:31], v[120:123], v[184:187], v[28:31]
    ds_write_b128 v10, v[52:55] offset:4096
    v_mfma_f32_16x16x32_bf16 v[32:35], v[124:127], v[184:187], v[32:35]
    s_mul_i32 s27, s32, 20480
    s_mul_i32 s28, s20, 160
    s_add_u32 s27, s27, s28
    s_waitcnt lgkmcnt(0)
    s_barrier
    ds_read_b128 v[88:91], v11 offset:0
    ds_read_b128 v[92:95], v11 offset:1024
    ds_read_b128 v[96:99], v11 offset:2048
    ds_read_b128 v[100:103], v11 offset:3072
    ds_read_b128 v[104:107], v11 offset:4096
    v_fmac_f32 v56, v16, v13
    v_fmac_f32 v57, v17, v13
    v_fmac_f32 v58, v18, v13
    v_fmac_f32 v59, v19, v13
    v_fmac_f32 v60, v20, v13
    v_fmac_f32 v61, v21, v13
    v_fmac_f32 v62, v22, v13
    v_fmac_f32 v63, v23, v13
    v_fmac_f32 v64, v24, v13
    v_fmac_f32 v65, v25, v13
    v_fmac_f32 v66, v26, v13
    v_fmac_f32 v67, v27, v13
    v_fmac_f32 v68, v28, v13
    v_fmac_f32 v69, v29, v13
    v_fmac_f32 v70, v30, v13
    v_fmac_f32 v71, v31, v13
    v_fmac_f32 v72, v32, v13
    v_fmac_f32 v73, v33, v13
    v_fmac_f32 v74, v34, v13
    v_fmac_f32 v75, v35, v13
    s_waitcnt lgkmcnt(4)
    v_fmac_f32 v56, v88, v13
    v_fmac_f32 v57, v89, v13
    v_fmac_f32 v58, v90, v13
    v_fmac_f32 v59, v91, v13
    v_cvt_pk_bf16_f32 v56, v56, v57
    v_cvt_pk_bf16_f32 v57, v58, v59
    ds_write_b64 v7, v[56:57] offset:0
    s_waitcnt lgkmcnt(4)
    v_fmac_f32 v60, v92, v13
    v_fmac_f32 v61, v93, v13
    v_fmac_f32 v62, v94, v13
    v_fmac_f32 v63, v95, v13
    v_cvt_pk_bf16_f32 v60, v60, v61
    v_cvt_pk_bf16_f32 v61, v62, v63
    ds_write_b64 v7, v[60:61] offset:32
    s_waitcnt lgkmcnt(4)
    v_fmac_f32 v64, v96, v13
    v_fmac_f32 v65, v97, v13
    v_fmac_f32 v66, v98, v13
    v_fmac_f32 v67, v99, v13
    v_cvt_pk_bf16_f32 v64, v64, v65
    v_cvt_pk_bf16_f32 v65, v66, v67
    ds_write_b64 v7, v[64:65] offset:64
    s_waitcnt lgkmcnt(4)
    v_fmac_f32 v68, v100, v13
    v_fmac_f32 v69, v101, v13
    v_fmac_f32 v70, v102, v13
    v_fmac_f32 v71, v103, v13
    v_cvt_pk_bf16_f32 v68, v68, v69
    v_cvt_pk_bf16_f32 v69, v70, v71
    ds_write_b64 v7, v[68:69] offset:96
    s_waitcnt lgkmcnt(4)
    v_fmac_f32 v72, v104, v13
    v_fmac_f32 v73, v105, v13
    v_fmac_f32 v74, v106, v13
    v_fmac_f32 v75, v107, v13
    v_cvt_pk_bf16_f32 v72, v72, v73
    v_cvt_pk_bf16_f32 v73, v74, v75
    ds_write_b64 v7, v[72:73] offset:128
    ds_read_b128 v[16:19], v241
    ds_read_b128 v[20:23], v242
    ds_read_b128 v[24:27], v243
    s_waitcnt lgkmcnt(2)
    buffer_store_dwordx4 v[16:19], v244, s[44:47], s27 offen
    s_waitcnt lgkmcnt(1)
    buffer_store_dwordx4 v[20:23], v245, s[44:47], s27 offen
    s_waitcnt lgkmcnt(0)
    s_mov_b32 exec_hi, 0
    buffer_store_dwordx4 v[24:27], v246, s[44:47], s27 offen
    s_mov_b32 exec_hi, -1
K3_END:
    s_endpgm
CODE_END:
    s_endpgm
.section .rodata,"a"
.p2align 6
.amdhsa_kernel k1_kernel
  .amdhsa_next_free_vgpr 168
  .amdhsa_next_free_sgpr 76
  .amdhsa_accum_offset 168
  .amdhsa_group_segment_fixed_size 0
  .amdhsa_kernarg_size 128
  .amdhsa_user_sgpr_count 2
  .amdhsa_user_sgpr_kernarg_segment_ptr 1
  .amdhsa_system_sgpr_workgroup_id_x 1
.end_amdhsa_kernel
.section .rodata,"a"
.p2align 6
.amdhsa_kernel k3_kernel
  .amdhsa_next_free_vgpr 247
  .amdhsa_next_free_sgpr 68
  .amdhsa_accum_offset 248
  .amdhsa_group_segment_fixed_size 0
  .amdhsa_kernarg_size 128
  .amdhsa_user_sgpr_count 2
  .amdhsa_user_sgpr_kernarg_segment_ptr 1
  .amdhsa_system_sgpr_workgroup_id_x 1
.end_amdhsa_kernel
```
